```python
import torch

def _softmax(x, axis=-1):
    return torch.softmax(x, dim=axis)
def _gelu(x):
    return torch.nn.functional.gelu(x, approximate="tanh")
def _silu(x):
    return torch.nn.functional.silu(x)
def _sigmoid(x):
    return torch.sigmoid(x)
def _layernorm(x, axis=-1, eps=1e-5):
    m = x.mean(dim=axis, keepdim=True)
    v = x.var(dim=axis, keepdim=True, unbiased=False)
    return (x - m) / torch.sqrt(v + eps)
def _scatter_add(tgt, idx, src, axis=0):
    return tgt.clone().index_add_(axis, idx, src)
def _segment_sum(src, seg, n):
    out = torch.zeros((n,) + src.shape[1:], dtype=src.dtype)
    return out.index_add_(0, seg, src)
def _pad(x, pw):
    flat = tuple(v for pair in reversed(pw) for v in pair)
    return torch.nn.functional.pad(x, flat)

kernel_name = 'standalone__gqa_block_cached__near_ridge'

def setup_inputs():

    _w = (lambda a: (lambda t: t.to(torch.bfloat16) if t.is_floating_point() else t)(torch.as_tensor(a)))
    B, Sq, D = 8, 112, 576
    Hq, Hkv, Sk, Dh = 32, 16, 1024, 128
    assert Hq % Hkv == 0, (Hq, Hkv)
    return {
        "x": _w((lambda *s: torch.randn(*s, dtype=torch.bfloat16) * 0.8)(B, Sq, D)),
        "k_cache": _w((lambda *s: torch.randn(*s, dtype=torch.bfloat16) * 0.8)(B, Hkv, Sk, Dh)),
        "v_cache": _w((lambda *s: torch.randn(*s, dtype=torch.bfloat16) * 0.05)(B, Hkv, Sk, Dh)),
        "wq": _w((lambda *s: torch.randn(*s, dtype=torch.bfloat16) * 0.8)(D, Hq * Dh) * (D ** -0.5)),
        "wo": _w((lambda *s: torch.randn(*s, dtype=torch.bfloat16) * 0.05)(Hq * Dh, D) * ((Hq * Dh) ** -0.5)),
    }

def reference(x, k_cache, v_cache, wq, wo):
    B, Sq, D = x.shape
    Hq, Dh = 32, 128
    Hkv = k_cache.shape[1]
    rep = Hq // Hkv
    q = (lambda x, *d: x.permute(*d))((x @ wq).reshape(B, Sq, Hq, Dh), 0, 2, 1, 3)
    k = (lambda x, n, axis: torch.repeat_interleave(x, n, dim=axis))(k_cache, rep, axis=1)
    v = (lambda x, n, axis: torch.repeat_interleave(x, n, dim=axis))(v_cache, rep, axis=1)
    scores = torch.einsum("bhqd,bhkd->bhqk", q, k) * (Dh ** -0.5)
    p = _softmax(scores, axis=-1)
    o = torch.einsum("bhqk,bhkd->bhqd", p, v)
    return (lambda x, *d: x.permute(*d))(o, 0, 2, 1, 3).reshape(B, Sq, Hq * Dh) @ wo
```

```asm
; @launch grid=(256,1,1) block=(512,1,1) lds=163840
.amdgcn_target "amdgcn-amd-amdhsa--gfx950"
.text
.globl standalone__gqa_block_cached__near_ridge_kernel
.p2align 8
.type standalone__gqa_block_cached__near_ridge_kernel,@function
standalone__gqa_block_cached__near_ridge_kernel:
    s_load_dwordx16 s[4:19], s[0:1], 0
    v_lshrrev_b32 v1, 6, v0
    s_cmp_ge_u32 s2, 256
    s_cbranch_scc1 L_end
    v_and_b32 v0, 63, v0
    v_readfirstlane_b32 s23, v1
    s_and_b32 s24, s2, 7
    s_lshr_b32 s25, s2, 3
    s_lshr_b32 s20, s25, 2
    s_and_b32 s25, s25, 3
    s_lshl_b32 s21, s24, 2
    s_add_u32 s21, s21, s25
    s_lshr_b32 s22, s21, 1
    v_lshrrev_b32 v1, 4, v0
    v_and_b32 v2, 15, v0
    s_cmp_lt_u32 s23, 4
    s_cbranch_scc1 L_cons
    s_setprio 2
    s_cmp_eq_u32 s23, 5
    s_cbranch_scc1 L_prodX
    s_cmp_eq_u32 s23, 6
    s_cbranch_scc1 L_prodK
    s_cmp_eq_u32 s23, 7
    s_cbranch_scc1 L_prodV
    v_lshlrev_b32 v3, 2, v1
    v_xor_b32 v3, v3, v2
    v_lshlrev_b32 v3, 4, v3
    v_lshlrev_b32 v4, 13, v1
    v_add_u32 v4, v4, v3
    s_lshl_b32 s24, s21, 8
    s_waitcnt lgkmcnt(0)
    s_add_u32 s32, s10, s24
    s_addc_u32 s33, s11, 0
    s_sub_u32 s34, 4718592, s24
    s_mov_b32 s35, 0x20000
    s_and_b32 s43, s21, 3
    s_lshl_b32 s43, s43, 1
    s_add_u32 s43, s43, s20
    s_lshl_b32 s43, s43, 1
    s_cmp_ge_u32 s43, 18
    s_cselect_b32 s45, 18, 0
    s_sub_u32 s43, s43, s45
    s_mul_i32 s45, s43, 262144
    s_mov_b32 s46, 8192
    s_mov_b32 s44, 0
L_w_pre:
    s_add_u32 m0, s46, 0
    s_add_u32 s49, s45, 0
    buffer_load_dwordx4 v4, s[32:35], s49 offen offset:0 lds
    s_add_u32 s49, s45, 31744
    buffer_load_dwordx4 v4, s[32:35], s49 offen offset:1024 lds
    s_add_u32 s49, s45, 63488
    buffer_load_dwordx4 v4, s[32:35], s49 offen offset:2048 lds
    s_add_u32 s49, s45, 95232
    buffer_load_dwordx4 v4, s[32:35], s49 offen offset:3072 lds
    s_add_u32 m0, s46, 4096
    s_add_u32 s49, s45, 131072
    buffer_load_dwordx4 v4, s[32:35], s49 offen offset:0 lds
    s_add_u32 s49, s45, 162816
    buffer_load_dwordx4 v4, s[32:35], s49 offen offset:1024 lds
    s_add_u32 s49, s45, 194560
    buffer_load_dwordx4 v4, s[32:35], s49 offen offset:2048 lds
    s_add_u32 s49, s45, 226304
    buffer_load_dwordx4 v4, s[32:35], s49 offen offset:3072 lds
    s_add_u32 s43, s43, 1
    s_add_u32 s45, s45, 262144
    s_cmp_eq_u32 s43, 18
    s_cselect_b32 s43, 0, s43
    s_cselect_b32 s45, 0, s45
    s_add_u32 s46, s46, 8192
    s_cmp_eq_u32 s46, 81920
    s_cselect_b32 s46, 8192, s46
    s_add_u32 s44, s44, 1
    s_cmp_lt_u32 s44, 7
    s_cbranch_scc1 L_w_pre
    s_mov_b32 s44, 0
L_w_lp0:
    s_waitcnt vmcnt(32)
    s_barrier
    s_add_u32 m0, s46, 0
    s_add_u32 s49, s45, 0
    buffer_load_dwordx4 v4, s[32:35], s49 offen offset:0 lds
    s_add_u32 s49, s45, 31744
    buffer_load_dwordx4 v4, s[32:35], s49 offen offset:1024 lds
    s_add_u32 s49, s45, 63488
    buffer_load_dwordx4 v4, s[32:35], s49 offen offset:2048 lds
    s_add_u32 s49, s45, 95232
    buffer_load_dwordx4 v4, s[32:35], s49 offen offset:3072 lds
    s_add_u32 m0, s46, 4096
    s_add_u32 s49, s45, 131072
    buffer_load_dwordx4 v4, s[32:35], s49 offen offset:0 lds
    s_add_u32 s49, s45, 162816
    buffer_load_dwordx4 v4, s[32:35], s49 offen offset:1024 lds
    s_add_u32 s49, s45, 194560
    buffer_load_dwordx4 v4, s[32:35], s49 offen offset:2048 lds
    s_add_u32 s49, s45, 226304
    buffer_load_dwordx4 v4, s[32:35], s49 offen offset:3072 lds
    s_add_u32 s43, s43, 1
    s_add_u32 s45, s45, 262144
    s_cmp_eq_u32 s43, 18
    s_cselect_b32 s43, 0, s43
    s_cselect_b32 s45, 0, s45
    s_add_u32 s46, s46, 8192
    s_cmp_eq_u32 s46, 81920
    s_cselect_b32 s46, 8192, s46
    s_add_u32 m0, s46, 0
    s_add_u32 s49, s45, 0
    buffer_load_dwordx4 v4, s[32:35], s49 offen offset:0 lds
    s_add_u32 s49, s45, 31744
    buffer_load_dwordx4 v4, s[32:35], s49 offen offset:1024 lds
    s_add_u32 s49, s45, 63488
    buffer_load_dwordx4 v4, s[32:35], s49 offen offset:2048 lds
    s_add_u32 s49, s45, 95232
    buffer_load_dwordx4 v4, s[32:35], s49 offen offset:3072 lds
    s_add_u32 m0, s46, 4096
    s_add_u32 s49, s45, 131072
    buffer_load_dwordx4 v4, s[32:35], s49 offen offset:0 lds
    s_add_u32 s49, s45, 162816
    buffer_load_dwordx4 v4, s[32:35], s49 offen offset:1024 lds
    s_add_u32 s49, s45, 194560
    buffer_load_dwordx4 v4, s[32:35], s49 offen offset:2048 lds
    s_add_u32 s49, s45, 226304
    buffer_load_dwordx4 v4, s[32:35], s49 offen offset:3072 lds
    s_add_u32 s43, s43, 1
    s_add_u32 s45, s45, 262144
    s_cmp_eq_u32 s43, 18
    s_cselect_b32 s43, 0, s43
    s_cselect_b32 s45, 0, s45
    s_add_u32 s46, s46, 8192
    s_cmp_eq_u32 s46, 81920
    s_cselect_b32 s46, 8192, s46
    s_add_u32 s44, s44, 1
    s_cmp_lt_u32 s44, 5
    s_cbranch_scc1 L_w_lp0
    s_waitcnt vmcnt(32)
    s_barrier
    s_add_u32 m0, s46, 0
    s_add_u32 s49, s45, 0
    buffer_load_dwordx4 v4, s[32:35], s49 offen offset:0 lds
    s_add_u32 s49, s45, 31744
    buffer_load_dwordx4 v4, s[32:35], s49 offen offset:1024 lds
    s_add_u32 s49, s45, 63488
    buffer_load_dwordx4 v4, s[32:35], s49 offen offset:2048 lds
    s_add_u32 s49, s45, 95232
    buffer_load_dwordx4 v4, s[32:35], s49 offen offset:3072 lds
    s_add_u32 m0, s46, 4096
    s_add_u32 s49, s45, 131072
    buffer_load_dwordx4 v4, s[32:35], s49 offen offset:0 lds
    s_add_u32 s49, s45, 162816
    buffer_load_dwordx4 v4, s[32:35], s49 offen offset:1024 lds
    s_add_u32 s49, s45, 194560
    buffer_load_dwordx4 v4, s[32:35], s49 offen offset:2048 lds
    s_add_u32 s49, s45, 226304
    buffer_load_dwordx4 v4, s[32:35], s49 offen offset:3072 lds
    s_add_u32 s43, s43, 1
    s_add_u32 s45, s45, 262144
    s_cmp_eq_u32 s43, 18
    s_cselect_b32 s43, 0, s43
    s_cselect_b32 s45, 0, s45
    s_add_u32 s46, s46, 8192
    s_cmp_eq_u32 s46, 81920
    s_cselect_b32 s46, 8192, s46
    s_waitcnt vmcnt(24)
    s_barrier
    s_waitcnt vmcnt(8)
    s_barrier
    s_waitcnt vmcnt(0)
    s_barrier
    s_and_b32 s28, s2, 7
    s_lshr_b32 s29, s2, 3
    s_and_b32 s30, s28, 3
    s_lshr_b32 s28, s28, 2
    s_lshl_b32 s28, s28, 5
    s_add_u32 s29, s29, s28
    s_mul_hi_u32 s59, s29, 613566757
    s_mul_i32 s28, s59, 7
    s_sub_u32 s28, s29, s28
    s_mul_i32 s58, s30, 7
    s_add_u32 s58, s58, s28
    s_mov_b32 s57, 0
    v_lshrrev_b32 v5, 3, v0
    s_mov_b32 s24, 1152
    v_mul_lo_u32 v5, v5, s24
    v_bfe_u32 v10, v0, 4, 1
    v_lshlrev_b32 v10, 2, v10
    v_and_b32 v11, 7, v0
    v_xor_b32 v10, v10, v11
    v_lshlrev_b32 v10, 4, v10
    v_add_u32 v5, v5, v10
    s_mov_b32 s36, s12
    s_mov_b32 s37, s13
    s_mov_b32 s38, 4718592
    s_mov_b32 s39, 0x20000
    s_sub_u32 s63, s23, 4
    s_lshl_b32 s61, s63, 14
    s_add_u32 s61, s61, 65536
L_helper0:
    v_lshrrev_b32 v3, 5, v0
    v_and_b32 v6, 15, v0
    v_lshrrev_b32 v6, 2, v6
    v_lshlrev_b32 v7, 2, v3
    v_add_u32 v7, v7, v6
    v_lshlrev_b32 v7, 7, v7
    v_bfe_u32 v10, v0, 4, 1
    v_lshlrev_b32 v10, 5, v10
    v_add_u32 v7, v7, v10
    v_and_b32 v10, 3, v0
    v_lshlrev_b32 v10, 3, v10
    v_add_u32 v7, v7, v10
    v_add_u32 v7, s61, v7
    v_lshrrev_b32 v6, 1, v6
    v_lshlrev_b32 v6, 6, v6
    v_add_u32 v8, v7, v6
    v_xor_b32 v6, 64, v6
    v_add_u32 v9, v7, v6
    s_mov_b32 s40, s18
    s_mov_b32 s41, s19
    s_mov_b32 s42, 7340032
    s_mov_b32 s43, 0x20000
    v_bfe_u32 v2, v0, 4, 1
    v_lshlrev_b32 v2, 17, v2
    v_lshlrev_b32 v4, 8, v3
    v_add_u32 v2, v2, v4
    v_and_b32 v4, 15, v0
    v_lshlrev_b32 v4, 4, v4
    v_add_u32 v2, v2, v4
    s_lshl_b32 s28, s58, 9
    s_lshl_b32 s44, s63, 6
    s_add_u32 s28, s28, s44
    s_add_u32 s28, s28, 48
    s_lshl_b32 s28, s28, 9
    v_mov_b32 v16, 0
    v_mov_b32 v17, 0
    v_mov_b32 v18, 0
    v_mov_b32 v19, 0
    v_mov_b32 v20, 0
    v_mov_b32 v21, 0
    v_mov_b32 v22, 0
    v_mov_b32 v23, 0
    v_mov_b32 v24, 0
    v_mov_b32 v25, 0
    v_mov_b32 v26, 0
    v_mov_b32 v27, 0
    v_mov_b32 v28, 0
    v_mov_b32 v29, 0
    v_mov_b32 v30, 0
    v_mov_b32 v31, 0
    v_mov_b32 v32, 0
    v_mov_b32 v33, 0
    v_mov_b32 v34, 0
    v_mov_b32 v35, 0
    v_mov_b32 v36, 0
    v_mov_b32 v37, 0
    v_mov_b32 v38, 0
    v_mov_b32 v39, 0
    v_mov_b32 v40, 0
    v_mov_b32 v41, 0
    v_mov_b32 v42, 0
    v_mov_b32 v43, 0
    v_mov_b32 v44, 0
    v_mov_b32 v45, 0
    v_mov_b32 v46, 0
    v_mov_b32 v47, 0
    s_mov_b32 s44, 0
L_h0pre:
    s_barrier
    s_add_u32 s44, s44, 1
    s_cmp_lt_u32 s44, 7
    s_cbranch_scc1 L_h0pre
    v_lshlrev_b32 v12, 4, v0
    s_mul_i32 s45, s2, 18432
    s_lshl_b32 s44, s63, 10
    s_add_u32 s45, s45, s44
    s_barrier
    ds_read_b64_tr_b16 a[0:1], v8 offset:0
    ds_read_b64_tr_b16 a[2:3], v8 offset:1024
    ds_read_b64_tr_b16 a[4:5], v9 offset:0
    ds_read_b64_tr_b16 a[6:7], v9 offset:1024
    buffer_load_dwordx4 v[48:51], v12, s[36:39], s45 offen
    s_add_u32 s45, s45, 2048
    s_waitcnt lgkmcnt(0)
    s_barrier
    ds_read_b64_tr_b16 a[8:9], v8 offset:2048
    ds_read_b64_tr_b16 a[10:11], v8 offset:3072
    ds_read_b64_tr_b16 a[12:13], v9 offset:2048
    ds_read_b64_tr_b16 a[14:15], v9 offset:3072
    buffer_load_dwordx4 v[52:55], v12, s[36:39], s45 offen
    s_add_u32 s45, s45, 2048
    s_waitcnt lgkmcnt(0)
    s_barrier
    ds_read_b64_tr_b16 a[16:17], v8 offset:4096
    ds_read_b64_tr_b16 a[18:19], v8 offset:5120
    ds_read_b64_tr_b16 a[20:21], v9 offset:4096
    ds_read_b64_tr_b16 a[22:23], v9 offset:5120
    buffer_load_dwordx4 v[56:59], v12, s[36:39], s45 offen
    s_add_u32 s45, s45, 2048
    s_waitcnt lgkmcnt(0)
    s_barrier
    ds_read_b64_tr_b16 a[24:25], v8 offset:6144
    ds_read_b64_tr_b16 a[26:27], v8 offset:7168
    ds_read_b64_tr_b16 a[28:29], v9 offset:6144
    ds_read_b64_tr_b16 a[30:31], v9 offset:7168
    buffer_load_dwordx4 v[60:63], v12, s[36:39], s45 offen
    s_add_u32 s45, s45, 2048
    s_waitcnt lgkmcnt(0)
    s_barrier
    ds_read_b64_tr_b16 a[32:33], v8 offset:8192
    ds_read_b64_tr_b16 a[34:35], v8 offset:9216
    ds_read_b64_tr_b16 a[36:37], v9 offset:8192
    ds_read_b64_tr_b16 a[38:39], v9 offset:9216
    buffer_load_dwordx4 v[64:67], v12, s[36:39], s45 offen
    s_add_u32 s45, s45, 2048
    s_waitcnt lgkmcnt(0)
    s_barrier
    ds_read_b64_tr_b16 a[40:41], v8 offset:10240
    ds_read_b64_tr_b16 a[42:43], v8 offset:11264
    ds_read_b64_tr_b16 a[44:45], v9 offset:10240
    ds_read_b64_tr_b16 a[46:47], v9 offset:11264
    buffer_load_dwordx4 v[68:71], v12, s[36:39], s45 offen
    s_add_u32 s45, s45, 2048
    s_waitcnt lgkmcnt(0)
    s_barrier
    ds_read_b64_tr_b16 a[48:49], v8 offset:12288
    ds_read_b64_tr_b16 a[50:51], v8 offset:13312
    ds_read_b64_tr_b16 a[52:53], v9 offset:12288
    ds_read_b64_tr_b16 a[54:55], v9 offset:13312
    buffer_load_dwordx4 v[72:75], v12, s[36:39], s45 offen
    s_add_u32 s45, s45, 2048
    s_waitcnt lgkmcnt(0)
    s_barrier
    ds_read_b64_tr_b16 a[56:57], v8 offset:14336
    ds_read_b64_tr_b16 a[58:59], v8 offset:15360
    ds_read_b64_tr_b16 a[60:61], v9 offset:14336
    ds_read_b64_tr_b16 a[62:63], v9 offset:15360
    buffer_load_dwordx4 v[76:79], v12, s[36:39], s45 offen
    s_add_u32 s45, s45, 2048
    s_waitcnt lgkmcnt(0)
    s_barrier
    ds_read_b64_tr_b16 v[128:129], v8 offset:0
    ds_read_b64_tr_b16 v[130:131], v8 offset:1024
    ds_read_b64_tr_b16 v[132:133], v9 offset:0
    ds_read_b64_tr_b16 v[134:135], v9 offset:1024
    buffer_load_dwordx4 v[80:83], v12, s[36:39], s45 offen
    s_add_u32 s45, s45, 2048
    s_waitcnt lgkmcnt(0)
    s_barrier
    ds_read_b64_tr_b16 v[136:137], v8 offset:2048
    ds_read_b64_tr_b16 v[138:139], v8 offset:3072
    ds_read_b64_tr_b16 v[140:141], v9 offset:2048
    ds_read_b64_tr_b16 v[142:143], v9 offset:3072
    s_waitcnt lgkmcnt(0)
    s_barrier
    ds_read_b64_tr_b16 v[144:145], v8 offset:4096
    ds_read_b64_tr_b16 v[146:147], v8 offset:5120
    ds_read_b64_tr_b16 v[148:149], v9 offset:4096
    ds_read_b64_tr_b16 v[150:151], v9 offset:5120
    s_waitcnt lgkmcnt(0)
    s_barrier
    ds_read_b64_tr_b16 v[152:153], v8 offset:6144
    ds_read_b64_tr_b16 v[154:155], v8 offset:7168
    ds_read_b64_tr_b16 v[156:157], v9 offset:6144
    ds_read_b64_tr_b16 v[158:159], v9 offset:7168
    s_waitcnt lgkmcnt(0)
    s_barrier
    ds_read_b64_tr_b16 v[160:161], v8 offset:8192
    ds_read_b64_tr_b16 v[162:163], v8 offset:9216
    ds_read_b64_tr_b16 v[164:165], v9 offset:8192
    ds_read_b64_tr_b16 v[166:167], v9 offset:9216
    s_waitcnt lgkmcnt(0)
    s_barrier
    ds_read_b64_tr_b16 v[168:169], v8 offset:10240
    ds_read_b64_tr_b16 v[170:171], v8 offset:11264
    ds_read_b64_tr_b16 v[172:173], v9 offset:10240
    ds_read_b64_tr_b16 v[174:175], v9 offset:11264
    s_waitcnt lgkmcnt(0)
    s_barrier
    ds_read_b64_tr_b16 v[176:177], v8 offset:12288
    ds_read_b64_tr_b16 v[178:179], v8 offset:13312
    ds_read_b64_tr_b16 v[180:181], v9 offset:12288
    ds_read_b64_tr_b16 v[182:183], v9 offset:13312
    s_waitcnt lgkmcnt(0)
    s_barrier
    ds_read_b64_tr_b16 v[184:185], v8 offset:14336
    ds_read_b64_tr_b16 v[186:187], v8 offset:15360
    ds_read_b64_tr_b16 v[188:189], v9 offset:14336
    ds_read_b64_tr_b16 v[190:191], v9 offset:15360
    s_waitcnt lgkmcnt(0)
    s_mov_b32 s44, 0
L_hrest:
    s_barrier
    s_add_u32 s44, s44, 1
    s_cmp_lt_u32 s44, 11
    s_cbranch_scc1 L_hrest
    s_barrier
    s_waitcnt vmcnt(0)
    s_cmp_ge_u32 s2, 252
    s_cbranch_scc1 L_end
    s_mov_b32 s52, s16
    s_mov_b32 s53, s17
    s_mov_b32 s54, 256
    s_mov_b32 s55, 0x20000
    s_mov_b32 s66, 0
    s_mov_b32 s56, 0
L_epochh0:
    s_add_u32 s56, s56, 1
    s_cmp_lg_u32 s66, 0
    s_cbranch_scc1 L_epoch_okh0
    s_cmp_ge_u32 s56, 100000
    s_cbranch_scc1 L_epoch_okh0
    v_mov_b32 v14, 0
    buffer_load_dwordx2 v[12:13], v14, s[52:55], 0 offen offset:128 sc1
    s_waitcnt vmcnt(0)
    v_readfirstlane_b32 s66, v12
    v_readfirstlane_b32 s67, v13
    s_nop 3
    s_branch L_epochh0
L_epoch_okh0:
    s_add_u32 s52, s18, 8388608
    s_addc_u32 s53, s19, 0
    s_mov_b32 s54, 32768
    s_mov_b32 s55, 0x20000
    s_lshl_b32 s24, s58, 1
    s_mul_hi_u32 s25, s24, 613566757
    s_add_u32 s24, s24, 1
    s_mul_hi_u32 s24, s24, 613566757
    s_lshl_b32 s24, s24, 12
    s_lshl_b32 s25, s25, 12
    v_and_b32 v11, 7, v0
    v_lshlrev_b32 v11, 7, v11
    s_lshl_b32 s56, s63, 10
    v_add_u32 v11, s56, v11
    v_and_b32 v14, 8, v0
    v_mov_b32 v12, s25
    v_mov_b32 v13, s24
    v_cmp_eq_u32 vcc, 0, v14
    s_nop 1
    v_cndmask_b32 v12, v13, v12, vcc
    v_add_u32 v11, v11, v12
    s_mov_b32 s56, 0
    s_mov_b64 exec, 0xc0c0
L_pollh0:
    buffer_load_dwordx2 v[12:13], v11, s[52:55], 0 offen sc1
    s_waitcnt vmcnt(0)
    v_cmp_eq_u32 vcc, s66, v12
    v_cmp_eq_u32 s[68:69], s67, v13
    s_nop 1
    s_and_b64 s[68:69], s[68:69], vcc
    s_add_u32 s56, s56, 1
    s_cmp_eq_u64 s[68:69], 0xc0c0
    s_cbranch_scc1 L_polldh0
    s_cmp_ge_u32 s56, 100000
    s_cbranch_scc1 L_polldh0
    s_sleep 1
    s_branch L_pollh0
L_polldh0:
    s_mov_b64 exec, -1
    s_cmp_ge_u32 s2, 252
    s_cbranch_scc1 L_end
    buffer_load_dwordx4 v[48:51], v2, s[40:43], s28 offen sc1
    s_add_u32 s28, s28, 512
    buffer_load_dwordx4 v[52:55], v2, s[40:43], s28 offen sc1
    s_add_u32 s28, s28, 512
    buffer_load_dwordx4 v[56:59], v2, s[40:43], s28 offen sc1
    s_add_u32 s28, s28, 512
    buffer_load_dwordx4 v[60:63], v2, s[40:43], s28 offen sc1
    s_add_u32 s28, s28, 512
    buffer_load_dwordx4 v[64:67], v2, s[40:43], s28 offen sc1
    s_add_u32 s28, s28, 512
    buffer_load_dwordx4 v[68:71], v2, s[40:43], s28 offen sc1
    s_add_u32 s28, s28, 512
    buffer_load_dwordx4 v[72:75], v2, s[40:43], s28 offen sc1
    s_add_u32 s28, s28, 512
    buffer_load_dwordx4 v[76:79], v2, s[40:43], s28 offen sc1
    s_add_u32 s28, s28, 512
    buffer_load_dwordx4 v[80:83], v2, s[40:43], s28 offen sc1
    s_add_u32 s28, s28, 512
    buffer_load_dwordx4 v[84:87], v2, s[40:43], s28 offen sc1
    s_add_u32 s28, s28, 512
    buffer_load_dwordx4 v[88:91], v2, s[40:43], s28 offen sc1
    s_add_u32 s28, s28, 512
    buffer_load_dwordx4 v[92:95], v2, s[40:43], s28 offen sc1
    s_add_u32 s28, s28, 512
    buffer_load_dwordx4 v[96:99], v2, s[40:43], s28 offen sc1
    s_add_u32 s28, s28, 512
    buffer_load_dwordx4 v[100:103], v2, s[40:43], s28 offen sc1
    s_add_u32 s28, s28, 512
    buffer_load_dwordx4 v[104:107], v2, s[40:43], s28 offen sc1
    s_add_u32 s28, s28, 512
    buffer_load_dwordx4 v[108:111], v2, s[40:43], s28 offen sc1
    s_add_u32 s28, s28, 512
    s_waitcnt vmcnt(15)
    v_mfma_f32_32x32x16_bf16 v[16:31], a[0:3], v[48:51], v[16:31]
    v_mfma_f32_32x32x16_bf16 v[32:47], a[4:7], v[48:51], v[32:47]
    s_waitcnt vmcnt(14)
    v_mfma_f32_32x32x16_bf16 v[16:31], a[8:11], v[52:55], v[16:31]
    v_mfma_f32_32x32x16_bf16 v[32:47], a[12:15], v[52:55], v[32:47]
    s_waitcnt vmcnt(13)
    v_mfma_f32_32x32x16_bf16 v[16:31], a[16:19], v[56:59], v[16:31]
    v_mfma_f32_32x32x16_bf16 v[32:47], a[20:23], v[56:59], v[32:47]
    s_waitcnt vmcnt(12)
    v_mfma_f32_32x32x16_bf16 v[16:31], a[24:27], v[60:63], v[16:31]
    v_mfma_f32_32x32x16_bf16 v[32:47], a[28:31], v[60:63], v[32:47]
    s_waitcnt vmcnt(11)
    v_mfma_f32_32x32x16_bf16 v[16:31], a[32:35], v[64:67], v[16:31]
    v_mfma_f32_32x32x16_bf16 v[32:47], a[36:39], v[64:67], v[32:47]
    s_waitcnt vmcnt(10)
    v_mfma_f32_32x32x16_bf16 v[16:31], a[40:43], v[68:71], v[16:31]
    v_mfma_f32_32x32x16_bf16 v[32:47], a[44:47], v[68:71], v[32:47]
    s_waitcnt vmcnt(9)
    v_mfma_f32_32x32x16_bf16 v[16:31], a[48:51], v[72:75], v[16:31]
    v_mfma_f32_32x32x16_bf16 v[32:47], a[52:55], v[72:75], v[32:47]
    s_waitcnt vmcnt(8)
    v_mfma_f32_32x32x16_bf16 v[16:31], a[56:59], v[76:79], v[16:31]
    v_mfma_f32_32x32x16_bf16 v[32:47], a[60:63], v[76:79], v[32:47]
    s_waitcnt vmcnt(7)
    v_mfma_f32_32x32x16_bf16 v[16:31], v[128:131], v[80:83], v[16:31]
    v_mfma_f32_32x32x16_bf16 v[32:47], v[132:135], v[80:83], v[32:47]
    s_waitcnt vmcnt(6)
    v_mfma_f32_32x32x16_bf16 v[16:31], v[136:139], v[84:87], v[16:31]
    v_mfma_f32_32x32x16_bf16 v[32:47], v[140:143], v[84:87], v[32:47]
    s_waitcnt vmcnt(5)
    v_mfma_f32_32x32x16_bf16 v[16:31], v[144:147], v[88:91], v[16:31]
    v_mfma_f32_32x32x16_bf16 v[32:47], v[148:151], v[88:91], v[32:47]
    s_waitcnt vmcnt(4)
    v_mfma_f32_32x32x16_bf16 v[16:31], v[152:155], v[92:95], v[16:31]
    v_mfma_f32_32x32x16_bf16 v[32:47], v[156:159], v[92:95], v[32:47]
    s_waitcnt vmcnt(3)
    v_mfma_f32_32x32x16_bf16 v[16:31], v[160:163], v[96:99], v[16:31]
    v_mfma_f32_32x32x16_bf16 v[32:47], v[164:167], v[96:99], v[32:47]
    s_waitcnt vmcnt(2)
    v_mfma_f32_32x32x16_bf16 v[16:31], v[168:171], v[100:103], v[16:31]
    v_mfma_f32_32x32x16_bf16 v[32:47], v[172:175], v[100:103], v[32:47]
    s_waitcnt vmcnt(1)
    v_mfma_f32_32x32x16_bf16 v[16:31], v[176:179], v[104:107], v[16:31]
    v_mfma_f32_32x32x16_bf16 v[32:47], v[180:183], v[104:107], v[32:47]
    s_waitcnt vmcnt(0)
    v_mfma_f32_32x32x16_bf16 v[16:31], v[184:187], v[108:111], v[16:31]
    v_mfma_f32_32x32x16_bf16 v[32:47], v[188:191], v[108:111], v[32:47]
    s_nop 7
    s_nop 7
    s_barrier
    v_lshlrev_b32 v10, 4, v0
    s_lshl_b32 s24, s63, 13
    s_add_u32 s24, s24, 131072
    v_add_u32 v11, s24, v10
    ds_write_b128 v11, v[16:19] offset:0
    ds_write_b128 v11, v[20:23] offset:1024
    ds_write_b128 v11, v[24:27] offset:2048
    ds_write_b128 v11, v[28:31] offset:3072
    ds_write_b128 v11, v[32:35] offset:4096
    ds_write_b128 v11, v[36:39] offset:5120
    ds_write_b128 v11, v[40:43] offset:6144
    ds_write_b128 v11, v[44:47] offset:7168
    s_waitcnt lgkmcnt(0)
    s_barrier
    s_endpgm
L_prodX:
    v_lshrrev_b32 v3, 2, v0
    s_mov_b32 s24, 1152
    v_mul_lo_u32 v3, v3, s24
    v_and_b32 v2, 3, v0
    v_xor_b32 v2, v2, v1
    v_lshlrev_b32 v2, 4, v2
    v_add_u32 v4, v3, v2
    s_mul_i32 s24, s20, 129024
    s_waitcnt lgkmcnt(0)
    s_add_u32 s36, s4, s24
    s_addc_u32 s37, s5, 0
    s_mov_b32 s38, 129024
    s_mov_b32 s39, 0x20000
    s_and_b32 s43, s21, 3
    s_lshl_b32 s43, s43, 1
    s_add_u32 s43, s43, s20
    s_lshl_b32 s43, s43, 1
    s_cmp_ge_u32 s43, 18
    s_cselect_b32 s45, 18, 0
    s_sub_u32 s43, s43, s45
    s_mul_i32 s45, s43, 64
    s_mov_b32 s46, 106496
    s_mov_b32 s44, 0
L_x_pre:
    s_add_u32 m0, s46, 0
    s_add_u32 s49, s45, 0
    buffer_load_dwordx4 v4, s[36:39], s49 offen offset:0 lds
    s_add_u32 s49, s45, 17408
    buffer_load_dwordx4 v4, s[36:39], s49 offen offset:1024 lds
    s_add_u32 s49, s45, 34816
    buffer_load_dwordx4 v4, s[36:39], s49 offen offset:2048 lds
    s_add_u32 s49, s45, 52224
    buffer_load_dwordx4 v4, s[36:39], s49 offen offset:3072 lds
    s_add_u32 m0, s46, 4096
    s_add_u32 s49, s45, 73728
    buffer_load_dwordx4 v4, s[36:39], s49 offen offset:0 lds
    s_add_u32 s49, s45, 91136
    buffer_load_dwordx4 v4, s[36:39], s49 offen offset:1024 lds
    s_add_u32 s49, s45, 108544
    buffer_load_dwordx4 v4, s[36:39], s49 offen offset:2048 lds
    s_add_u32 s43, s43, 1
    s_add_u32 s45, s45, 64
    s_cmp_eq_u32 s43, 18
    s_cselect_b32 s43, 0, s43
    s_cselect_b32 s45, 0, s45
    s_add_u32 s46, s46, 8192
    s_cmp_eq_u32 s46, 163840
    s_cselect_b32 s46, 81920, s46
    s_cmp_eq_u32 s46, 98304
    s_cselect_b32 s46, 106496, s46
    s_add_u32 s44, s44, 1
    s_cmp_lt_u32 s44, 7
    s_cbranch_scc1 L_x_pre
    s_mov_b32 s44, 0
L_x_lp0:
    s_waitcnt vmcnt(28)
    s_barrier
    s_add_u32 m0, s46, 0
    s_add_u32 s49, s45, 0
    buffer_load_dwordx4 v4, s[36:39], s49 offen offset:0 lds
    s_add_u32 s49, s45, 17408
    buffer_load_dwordx4 v4, s[36:39], s49 offen offset:1024 lds
    s_add_u32 s49, s45, 34816
    buffer_load_dwordx4 v4, s[36:39], s49 offen offset:2048 lds
    s_add_u32 s49, s45, 52224
    buffer_load_dwordx4 v4, s[36:39], s49 offen offset:3072 lds
    s_add_u32 m0, s46, 4096
    s_add_u32 s49, s45, 73728
    buffer_load_dwordx4 v4, s[36:39], s49 offen offset:0 lds
    s_add_u32 s49, s45, 91136
    buffer_load_dwordx4 v4, s[36:39], s49 offen offset:1024 lds
    s_add_u32 s49, s45, 108544
    buffer_load_dwordx4 v4, s[36:39], s49 offen offset:2048 lds
    s_add_u32 s43, s43, 1
    s_add_u32 s45, s45, 64
    s_cmp_eq_u32 s43, 18
    s_cselect_b32 s43, 0, s43
    s_cselect_b32 s45, 0, s45
    s_add_u32 s46, s46, 8192
    s_cmp_eq_u32 s46, 163840
    s_cselect_b32 s46, 81920, s46
    s_cmp_eq_u32 s46, 98304
    s_cselect_b32 s46, 106496, s46
    s_add_u32 m0, s46, 0
    s_add_u32 s49, s45, 0
    buffer_load_dwordx4 v4, s[36:39], s49 offen offset:0 lds
    s_add_u32 s49, s45, 17408
    buffer_load_dwordx4 v4, s[36:39], s49 offen offset:1024 lds
    s_add_u32 s49, s45, 34816
    buffer_load_dwordx4 v4, s[36:39], s49 offen offset:2048 lds
    s_add_u32 s49, s45, 52224
    buffer_load_dwordx4 v4, s[36:39], s49 offen offset:3072 lds
    s_add_u32 m0, s46, 4096
    s_add_u32 s49, s45, 73728
    buffer_load_dwordx4 v4, s[36:39], s49 offen offset:0 lds
    s_add_u32 s49, s45, 91136
    buffer_load_dwordx4 v4, s[36:39], s49 offen offset:1024 lds
    s_add_u32 s49, s45, 108544
    buffer_load_dwordx4 v4, s[36:39], s49 offen offset:2048 lds
    s_add_u32 s43, s43, 1
    s_add_u32 s45, s45, 64
    s_cmp_eq_u32 s43, 18
    s_cselect_b32 s43, 0, s43
    s_cselect_b32 s45, 0, s45
    s_add_u32 s46, s46, 8192
    s_cmp_eq_u32 s46, 163840
    s_cselect_b32 s46, 81920, s46
    s_cmp_eq_u32 s46, 98304
    s_cselect_b32 s46, 106496, s46
    s_add_u32 s44, s44, 1
    s_cmp_lt_u32 s44, 5
    s_cbranch_scc1 L_x_lp0
    s_waitcnt vmcnt(28)
    s_barrier
    s_add_u32 m0, s46, 0
    s_add_u32 s49, s45, 0
    buffer_load_dwordx4 v4, s[36:39], s49 offen offset:0 lds
    s_add_u32 s49, s45, 17408
    buffer_load_dwordx4 v4, s[36:39], s49 offen offset:1024 lds
    s_add_u32 s49, s45, 34816
    buffer_load_dwordx4 v4, s[36:39], s49 offen offset:2048 lds
    s_add_u32 s49, s45, 52224
    buffer_load_dwordx4 v4, s[36:39], s49 offen offset:3072 lds
    s_add_u32 m0, s46, 4096
    s_add_u32 s49, s45, 73728
    buffer_load_dwordx4 v4, s[36:39], s49 offen offset:0 lds
    s_add_u32 s49, s45, 91136
    buffer_load_dwordx4 v4, s[36:39], s49 offen offset:1024 lds
    s_add_u32 s49, s45, 108544
    buffer_load_dwordx4 v4, s[36:39], s49 offen offset:2048 lds
    s_add_u32 s43, s43, 1
    s_add_u32 s45, s45, 64
    s_cmp_eq_u32 s43, 18
    s_cselect_b32 s43, 0, s43
    s_cselect_b32 s45, 0, s45
    s_add_u32 s46, s46, 8192
    s_cmp_eq_u32 s46, 163840
    s_cselect_b32 s46, 81920, s46
    s_cmp_eq_u32 s46, 98304
    s_cselect_b32 s46, 106496, s46
    s_waitcnt vmcnt(21)
    s_barrier
    s_waitcnt vmcnt(7)
    s_barrier
    s_waitcnt vmcnt(0)
    s_barrier
    s_and_b32 s28, s2, 7
    s_lshr_b32 s29, s2, 3
    s_and_b32 s30, s28, 3
    s_lshr_b32 s28, s28, 2
    s_lshl_b32 s28, s28, 5
    s_add_u32 s29, s29, s28
    s_mul_hi_u32 s59, s29, 613566757
    s_mul_i32 s28, s59, 7
    s_sub_u32 s28, s29, s28
    s_mul_i32 s58, s30, 7
    s_add_u32 s58, s58, s28
    s_mov_b32 s57, 0
    v_lshrrev_b32 v5, 3, v0
    s_mov_b32 s24, 1152
    v_mul_lo_u32 v5, v5, s24
    v_bfe_u32 v10, v0, 4, 1
    v_lshlrev_b32 v10, 2, v10
    v_and_b32 v11, 7, v0
    v_xor_b32 v10, v10, v11
    v_lshlrev_b32 v10, 4, v10
    v_add_u32 v5, v5, v10
    s_mov_b32 s36, s12
    s_mov_b32 s37, s13
    s_mov_b32 s38, 4718592
    s_mov_b32 s39, 0x20000
    s_sub_u32 s63, s23, 4
    s_lshl_b32 s61, s63, 14
    s_add_u32 s61, s61, 65536
    s_branch L_helper0
L_prodK:
    s_and_b32 s28, s2, 7
    s_lshr_b32 s29, s2, 3
    s_and_b32 s30, s28, 3
    s_lshr_b32 s28, s28, 2
    s_lshl_b32 s28, s28, 5
    s_add_u32 s29, s29, s28
    s_mul_hi_u32 s59, s29, 613566757
    s_mul_i32 s28, s59, 7
    s_sub_u32 s28, s29, s28
    s_mul_i32 s58, s30, 7
    s_add_u32 s58, s58, s28
    s_mov_b32 s57, 0
    v_lshrrev_b32 v12, 3, v0
    s_mov_b32 s24, 1152
    v_mul_lo_u32 v12, v12, s24
    v_bfe_u32 v10, v0, 4, 1
    v_lshlrev_b32 v10, 2, v10
    v_and_b32 v11, 7, v0
    v_xor_b32 v10, v10, v11
    v_lshlrev_b32 v10, 4, v10
    v_add_u32 v12, v12, v10
    v_lshlrev_b32 v8, 8, v1
    v_add_u32 v3, 0, v1
    v_xor_b32 v3, v3, v2
    v_lshlrev_b32 v3, 4, v3
    v_add_u32 v4, v3, v8
    v_add_u32 v3, 4, v1
    v_xor_b32 v3, v3, v2
    v_lshlrev_b32 v3, 4, v3
    v_add_u32 v5, v3, v8
    v_add_u32 v3, 8, v1
    v_xor_b32 v3, v3, v2
    v_lshlrev_b32 v3, 4, v3
    v_add_u32 v6, v3, v8
    v_add_u32 v3, 12, v1
    v_xor_b32 v3, v3, v2
    v_lshlrev_b32 v3, 4, v3
    v_add_u32 v7, v3, v8
    s_lshl_b32 s24, s20, 4
    s_add_u32 s24, s24, s22
    s_lshl_b32 s24, s24, 18
    s_mul_i32 s50, s59, 128
    s_add_u32 s50, s50, 884736
    s_mov_b32 s51, 65536
    s_waitcnt lgkmcnt(0)
    s_add_u32 s24, s6, s24
    s_addc_u32 s25, s7, 0
    s_mov_b32 s26, 262144
    s_mov_b32 s27, 0x20000
    s_mov_b32 s36, s12
    s_mov_b32 s37, s13
    s_mov_b32 s38, 4718592
    s_mov_b32 s39, 0x20000
    s_mov_b32 s45, 0
    s_mov_b32 s47, 0
    s_barrier
    s_barrier
    s_add_u32 s46, s47, 0
    s_add_u32 m0, s46, 0
    s_add_u32 s49, s45, 0
    buffer_load_dwordx4 v4, s[24:27], s49 offen offset:0 nt lds
    buffer_load_dwordx4 v5, s[24:27], s49 offen offset:1024 nt lds
    buffer_load_dwordx4 v6, s[24:27], s49 offen offset:2048 nt lds
    buffer_load_dwordx4 v7, s[24:27], s49 offen offset:3072 nt lds
    s_add_u32 m0, s46, 4096
    s_add_u32 s49, s45, 4096
    buffer_load_dwordx4 v4, s[24:27], s49 offen offset:0 nt lds
    buffer_load_dwordx4 v5, s[24:27], s49 offen offset:1024 nt lds
    buffer_load_dwordx4 v6, s[24:27], s49 offen offset:2048 nt lds
    buffer_load_dwordx4 v7, s[24:27], s49 offen offset:3072 nt lds
    s_add_u32 s45, s45, 8192
    s_add_u32 s47, s47, 8192
    s_and_b32 s47, s47, 0xffff
    s_barrier
    s_barrier
    s_barrier
    s_barrier
    s_add_u32 s46, s47, 0
    s_add_u32 m0, s46, 0
    s_add_u32 s49, s45, 0
    buffer_load_dwordx4 v4, s[24:27], s49 offen offset:0 nt lds
    buffer_load_dwordx4 v5, s[24:27], s49 offen offset:1024 nt lds
    buffer_load_dwordx4 v6, s[24:27], s49 offen offset:2048 nt lds
    buffer_load_dwordx4 v7, s[24:27], s49 offen offset:3072 nt lds
    s_add_u32 m0, s46, 4096
    s_add_u32 s49, s45, 4096
    buffer_load_dwordx4 v4, s[24:27], s49 offen offset:0 nt lds
    buffer_load_dwordx4 v5, s[24:27], s49 offen offset:1024 nt lds
    buffer_load_dwordx4 v6, s[24:27], s49 offen offset:2048 nt lds
    buffer_load_dwordx4 v7, s[24:27], s49 offen offset:3072 nt lds
    s_add_u32 s45, s45, 8192
    s_add_u32 s47, s47, 8192
    s_and_b32 s47, s47, 0xffff
    s_barrier
    s_add_u32 s46, s47, 0
    s_add_u32 m0, s46, 0
    s_add_u32 s49, s45, 0
    buffer_load_dwordx4 v4, s[24:27], s49 offen offset:0 nt lds
    buffer_load_dwordx4 v5, s[24:27], s49 offen offset:1024 nt lds
    buffer_load_dwordx4 v6, s[24:27], s49 offen offset:2048 nt lds
    buffer_load_dwordx4 v7, s[24:27], s49 offen offset:3072 nt lds
    s_add_u32 m0, s46, 4096
    s_add_u32 s49, s45, 4096
    buffer_load_dwordx4 v4, s[24:27], s49 offen offset:0 nt lds
    buffer_load_dwordx4 v5, s[24:27], s49 offen offset:1024 nt lds
    buffer_load_dwordx4 v6, s[24:27], s49 offen offset:2048 nt lds
    buffer_load_dwordx4 v7, s[24:27], s49 offen offset:3072 nt lds
    s_add_u32 s45, s45, 8192
    s_add_u32 s47, s47, 8192
    s_and_b32 s47, s47, 0xffff
    s_barrier
    s_add_u32 s46, s47, 0
    s_add_u32 m0, s46, 0
    s_add_u32 s49, s45, 0
    buffer_load_dwordx4 v4, s[24:27], s49 offen offset:0 nt lds
    buffer_load_dwordx4 v5, s[24:27], s49 offen offset:1024 nt lds
    buffer_load_dwordx4 v6, s[24:27], s49 offen offset:2048 nt lds
    buffer_load_dwordx4 v7, s[24:27], s49 offen offset:3072 nt lds
    s_add_u32 m0, s46, 4096
    s_add_u32 s49, s45, 4096
    buffer_load_dwordx4 v4, s[24:27], s49 offen offset:0 nt lds
    buffer_load_dwordx4 v5, s[24:27], s49 offen offset:1024 nt lds
    buffer_load_dwordx4 v6, s[24:27], s49 offen offset:2048 nt lds
    buffer_load_dwordx4 v7, s[24:27], s49 offen offset:3072 nt lds
    s_add_u32 s45, s45, 8192
    s_add_u32 s47, s47, 8192
    s_and_b32 s47, s47, 0xffff
    s_barrier
    s_add_u32 s46, s47, 0
    s_add_u32 m0, s46, 0
    s_add_u32 s49, s45, 0
    buffer_load_dwordx4 v4, s[24:27], s49 offen offset:0 nt lds
    buffer_load_dwordx4 v5, s[24:27], s49 offen offset:1024 nt lds
    buffer_load_dwordx4 v6, s[24:27], s49 offen offset:2048 nt lds
    buffer_load_dwordx4 v7, s[24:27], s49 offen offset:3072 nt lds
    s_add_u32 m0, s46, 4096
    s_add_u32 s49, s45, 4096
    buffer_load_dwordx4 v4, s[24:27], s49 offen offset:0 nt lds
    buffer_load_dwordx4 v5, s[24:27], s49 offen offset:1024 nt lds
    buffer_load_dwordx4 v6, s[24:27], s49 offen offset:2048 nt lds
    buffer_load_dwordx4 v7, s[24:27], s49 offen offset:3072 nt lds
    s_add_u32 s45, s45, 8192
    s_add_u32 s47, s47, 8192
    s_and_b32 s47, s47, 0xffff
    s_waitcnt vmcnt(32)
    s_barrier
    s_add_u32 s46, s47, 0
    s_add_u32 m0, s46, 0
    s_add_u32 s49, s45, 0
    buffer_load_dwordx4 v4, s[24:27], s49 offen offset:0 nt lds
    buffer_load_dwordx4 v5, s[24:27], s49 offen offset:1024 nt lds
    buffer_load_dwordx4 v6, s[24:27], s49 offen offset:2048 nt lds
    buffer_load_dwordx4 v7, s[24:27], s49 offen offset:3072 nt lds
    s_add_u32 m0, s46, 4096
    s_add_u32 s49, s45, 4096
    buffer_load_dwordx4 v4, s[24:27], s49 offen offset:0 nt lds
    buffer_load_dwordx4 v5, s[24:27], s49 offen offset:1024 nt lds
    buffer_load_dwordx4 v6, s[24:27], s49 offen offset:2048 nt lds
    buffer_load_dwordx4 v7, s[24:27], s49 offen offset:3072 nt lds
    s_add_u32 s45, s45, 8192
    s_add_u32 s47, s47, 8192
    s_and_b32 s47, s47, 0xffff
    s_mov_b32 m0, s51
    s_add_u32 s49, s50, 8192
    buffer_load_dwordx4 v12, s[36:39], s50 offen lds
    buffer_load_dwordx4 v12, s[36:39], s49 offen offset:1024 lds
    s_add_u32 s50, s50, 18432
    s_add_u32 s51, s51, 2048
    s_cmp_eq_u32 s51, 81920
    s_cselect_b32 s51, 65536, s51
    s_waitcnt vmcnt(34)
    s_barrier
    s_add_u32 s46, s47, 0
    s_add_u32 m0, s46, 0
    s_add_u32 s49, s45, 0
    buffer_load_dwordx4 v4, s[24:27], s49 offen offset:0 nt lds
    buffer_load_dwordx4 v5, s[24:27], s49 offen offset:1024 nt lds
    buffer_load_dwordx4 v6, s[24:27], s49 offen offset:2048 nt lds
    buffer_load_dwordx4 v7, s[24:27], s49 offen offset:3072 nt lds
    s_add_u32 m0, s46, 4096
    s_add_u32 s49, s45, 4096
    buffer_load_dwordx4 v4, s[24:27], s49 offen offset:0 nt lds
    buffer_load_dwordx4 v5, s[24:27], s49 offen offset:1024 nt lds
    buffer_load_dwordx4 v6, s[24:27], s49 offen offset:2048 nt lds
    buffer_load_dwordx4 v7, s[24:27], s49 offen offset:3072 nt lds
    s_add_u32 s45, s45, 8192
    s_add_u32 s47, s47, 8192
    s_and_b32 s47, s47, 0xffff
    s_mov_b32 m0, s51
    s_add_u32 s49, s50, 8192
    buffer_load_dwordx4 v12, s[36:39], s50 offen lds
    buffer_load_dwordx4 v12, s[36:39], s49 offen offset:1024 lds
    s_add_u32 s50, s50, 18432
    s_add_u32 s51, s51, 2048
    s_cmp_eq_u32 s51, 81920
    s_cselect_b32 s51, 65536, s51
    s_waitcnt vmcnt(36)
    s_barrier
    s_add_u32 s46, s47, 0
    s_add_u32 m0, s46, 0
    s_add_u32 s49, s45, 0
    buffer_load_dwordx4 v4, s[24:27], s49 offen offset:0 nt lds
    buffer_load_dwordx4 v5, s[24:27], s49 offen offset:1024 nt lds
    buffer_load_dwordx4 v6, s[24:27], s49 offen offset:2048 nt lds
    buffer_load_dwordx4 v7, s[24:27], s49 offen offset:3072 nt lds
    s_add_u32 m0, s46, 4096
    s_add_u32 s49, s45, 4096
    buffer_load_dwordx4 v4, s[24:27], s49 offen offset:0 nt lds
    buffer_load_dwordx4 v5, s[24:27], s49 offen offset:1024 nt lds
    buffer_load_dwordx4 v6, s[24:27], s49 offen offset:2048 nt lds
    buffer_load_dwordx4 v7, s[24:27], s49 offen offset:3072 nt lds
    s_add_u32 s45, s45, 8192
    s_add_u32 s47, s47, 8192
    s_and_b32 s47, s47, 0xffff
    s_mov_b32 m0, s51
    s_add_u32 s49, s50, 8192
    buffer_load_dwordx4 v12, s[36:39], s50 offen lds
    buffer_load_dwordx4 v12, s[36:39], s49 offen offset:1024 lds
    s_add_u32 s50, s50, 18432
    s_add_u32 s51, s51, 2048
    s_cmp_eq_u32 s51, 81920
    s_cselect_b32 s51, 65536, s51
    s_waitcnt vmcnt(38)
    s_barrier
    s_add_u32 s46, s47, 0
    s_add_u32 m0, s46, 0
    s_add_u32 s49, s45, 0
    buffer_load_dwordx4 v4, s[24:27], s49 offen offset:0 nt lds
    buffer_load_dwordx4 v5, s[24:27], s49 offen offset:1024 nt lds
    buffer_load_dwordx4 v6, s[24:27], s49 offen offset:2048 nt lds
    buffer_load_dwordx4 v7, s[24:27], s49 offen offset:3072 nt lds
    s_add_u32 m0, s46, 4096
    s_add_u32 s49, s45, 4096
    buffer_load_dwordx4 v4, s[24:27], s49 offen offset:0 nt lds
    buffer_load_dwordx4 v5, s[24:27], s49 offen offset:1024 nt lds
    buffer_load_dwordx4 v6, s[24:27], s49 offen offset:2048 nt lds
    buffer_load_dwordx4 v7, s[24:27], s49 offen offset:3072 nt lds
    s_add_u32 s45, s45, 8192
    s_add_u32 s47, s47, 8192
    s_and_b32 s47, s47, 0xffff
    s_mov_b32 m0, s51
    s_add_u32 s49, s50, 8192
    buffer_load_dwordx4 v12, s[36:39], s50 offen lds
    buffer_load_dwordx4 v12, s[36:39], s49 offen offset:1024 lds
    s_add_u32 s50, s50, 18432
    s_add_u32 s51, s51, 2048
    s_cmp_eq_u32 s51, 81920
    s_cselect_b32 s51, 65536, s51
    s_waitcnt vmcnt(40)
    s_barrier
    s_add_u32 s46, s47, 0
    s_add_u32 m0, s46, 0
    s_add_u32 s49, s45, 0
    buffer_load_dwordx4 v4, s[24:27], s49 offen offset:0 nt lds
    buffer_load_dwordx4 v5, s[24:27], s49 offen offset:1024 nt lds
    buffer_load_dwordx4 v6, s[24:27], s49 offen offset:2048 nt lds
    buffer_load_dwordx4 v7, s[24:27], s49 offen offset:3072 nt lds
    s_add_u32 m0, s46, 4096
    s_add_u32 s49, s45, 4096
    buffer_load_dwordx4 v4, s[24:27], s49 offen offset:0 nt lds
    buffer_load_dwordx4 v5, s[24:27], s49 offen offset:1024 nt lds
    buffer_load_dwordx4 v6, s[24:27], s49 offen offset:2048 nt lds
    buffer_load_dwordx4 v7, s[24:27], s49 offen offset:3072 nt lds
    s_add_u32 s45, s45, 8192
    s_add_u32 s47, s47, 8192
    s_and_b32 s47, s47, 0xffff
    s_mov_b32 m0, s51
    s_add_u32 s49, s50, 8192
    buffer_load_dwordx4 v12, s[36:39], s50 offen lds
    buffer_load_dwordx4 v12, s[36:39], s49 offen offset:1024 lds
    s_add_u32 s50, s50, 18432
    s_add_u32 s51, s51, 2048
    s_cmp_eq_u32 s51, 81920
    s_cselect_b32 s51, 65536, s51
    s_mov_b32 s44, 0
L_K_lp0:
    s_waitcnt vmcnt(42)
    s_barrier
    s_add_u32 s46, s47, 0
    s_add_u32 m0, s46, 0
    s_add_u32 s49, s45, 0
    buffer_load_dwordx4 v4, s[24:27], s49 offen offset:0 nt lds
    buffer_load_dwordx4 v5, s[24:27], s49 offen offset:1024 nt lds
    buffer_load_dwordx4 v6, s[24:27], s49 offen offset:2048 nt lds
    buffer_load_dwordx4 v7, s[24:27], s49 offen offset:3072 nt lds
    s_add_u32 m0, s46, 4096
    s_add_u32 s49, s45, 4096
    buffer_load_dwordx4 v4, s[24:27], s49 offen offset:0 nt lds
    buffer_load_dwordx4 v5, s[24:27], s49 offen offset:1024 nt lds
    buffer_load_dwordx4 v6, s[24:27], s49 offen offset:2048 nt lds
    buffer_load_dwordx4 v7, s[24:27], s49 offen offset:3072 nt lds
    s_add_u32 s45, s45, 8192
    s_add_u32 s47, s47, 8192
    s_and_b32 s47, s47, 0xffff
    s_mov_b32 m0, s51
    s_add_u32 s49, s50, 8192
    buffer_load_dwordx4 v12, s[36:39], s50 offen lds
    buffer_load_dwordx4 v12, s[36:39], s49 offen offset:1024 lds
    s_add_u32 s50, s50, 18432
    s_add_u32 s51, s51, 2048
    s_cmp_eq_u32 s51, 81920
    s_cselect_b32 s51, 65536, s51
    s_add_u32 s44, s44, 1
    s_cmp_lt_u32 s44, 11
    s_cbranch_scc1 L_K_lp0
    s_waitcnt vmcnt(42)
    s_barrier
    s_add_u32 s46, s47, 0
    s_add_u32 m0, s46, 0
    s_add_u32 s49, s45, 0
    buffer_load_dwordx4 v4, s[24:27], s49 offen offset:0 nt lds
    buffer_load_dwordx4 v5, s[24:27], s49 offen offset:1024 nt lds
    buffer_load_dwordx4 v6, s[24:27], s49 offen offset:2048 nt lds
    buffer_load_dwordx4 v7, s[24:27], s49 offen offset:3072 nt lds
    s_add_u32 m0, s46, 4096
    s_add_u32 s49, s45, 4096
    buffer_load_dwordx4 v4, s[24:27], s49 offen offset:0 nt lds
    buffer_load_dwordx4 v5, s[24:27], s49 offen offset:1024 nt lds
    buffer_load_dwordx4 v6, s[24:27], s49 offen offset:2048 nt lds
    buffer_load_dwordx4 v7, s[24:27], s49 offen offset:3072 nt lds
    s_add_u32 s45, s45, 8192
    s_add_u32 s47, s47, 8192
    s_and_b32 s47, s47, 0xffff
    s_waitcnt vmcnt(40)
    s_barrier
    s_add_u32 s46, s47, 0
    s_add_u32 m0, s46, 0
    s_add_u32 s49, s45, 0
    buffer_load_dwordx4 v4, s[24:27], s49 offen offset:0 nt lds
    buffer_load_dwordx4 v5, s[24:27], s49 offen offset:1024 nt lds
    buffer_load_dwordx4 v6, s[24:27], s49 offen offset:2048 nt lds
    buffer_load_dwordx4 v7, s[24:27], s49 offen offset:3072 nt lds
    s_add_u32 m0, s46, 4096
    s_add_u32 s49, s45, 4096
    buffer_load_dwordx4 v4, s[24:27], s49 offen offset:0 nt lds
    buffer_load_dwordx4 v5, s[24:27], s49 offen offset:1024 nt lds
    buffer_load_dwordx4 v6, s[24:27], s49 offen offset:2048 nt lds
    buffer_load_dwordx4 v7, s[24:27], s49 offen offset:3072 nt lds
    s_add_u32 s45, s45, 8192
    s_add_u32 s47, s47, 8192
    s_and_b32 s47, s47, 0xffff
    s_waitcnt vmcnt(38)
    s_barrier
    s_add_u32 s46, s47, 0
    s_add_u32 m0, s46, 0
    s_add_u32 s49, s45, 0
    buffer_load_dwordx4 v4, s[24:27], s49 offen offset:0 nt lds
    buffer_load_dwordx4 v5, s[24:27], s49 offen offset:1024 nt lds
    buffer_load_dwordx4 v6, s[24:27], s49 offen offset:2048 nt lds
    buffer_load_dwordx4 v7, s[24:27], s49 offen offset:3072 nt lds
    s_add_u32 m0, s46, 4096
    s_add_u32 s49, s45, 4096
    buffer_load_dwordx4 v4, s[24:27], s49 offen offset:0 nt lds
    buffer_load_dwordx4 v5, s[24:27], s49 offen offset:1024 nt lds
    buffer_load_dwordx4 v6, s[24:27], s49 offen offset:2048 nt lds
    buffer_load_dwordx4 v7, s[24:27], s49 offen offset:3072 nt lds
    s_add_u32 s45, s45, 8192
    s_add_u32 s47, s47, 8192
    s_and_b32 s47, s47, 0xffff
    s_waitcnt vmcnt(36)
    s_barrier
    s_add_u32 s46, s47, 0
    s_add_u32 m0, s46, 0
    s_add_u32 s49, s45, 0
    buffer_load_dwordx4 v4, s[24:27], s49 offen offset:0 nt lds
    buffer_load_dwordx4 v5, s[24:27], s49 offen offset:1024 nt lds
    buffer_load_dwordx4 v6, s[24:27], s49 offen offset:2048 nt lds
    buffer_load_dwordx4 v7, s[24:27], s49 offen offset:3072 nt lds
    s_add_u32 m0, s46, 4096
    s_add_u32 s49, s45, 4096
    buffer_load_dwordx4 v4, s[24:27], s49 offen offset:0 nt lds
    buffer_load_dwordx4 v5, s[24:27], s49 offen offset:1024 nt lds
    buffer_load_dwordx4 v6, s[24:27], s49 offen offset:2048 nt lds
    buffer_load_dwordx4 v7, s[24:27], s49 offen offset:3072 nt lds
    s_add_u32 s45, s45, 8192
    s_add_u32 s47, s47, 8192
    s_and_b32 s47, s47, 0xffff
    s_waitcnt vmcnt(34)
    s_barrier
    s_add_u32 s46, s47, 0
    s_add_u32 m0, s46, 0
    s_add_u32 s49, s45, 0
    buffer_load_dwordx4 v4, s[24:27], s49 offen offset:0 nt lds
    buffer_load_dwordx4 v5, s[24:27], s49 offen offset:1024 nt lds
    buffer_load_dwordx4 v6, s[24:27], s49 offen offset:2048 nt lds
    buffer_load_dwordx4 v7, s[24:27], s49 offen offset:3072 nt lds
    s_add_u32 m0, s46, 4096
    s_add_u32 s49, s45, 4096
    buffer_load_dwordx4 v4, s[24:27], s49 offen offset:0 nt lds
    buffer_load_dwordx4 v5, s[24:27], s49 offen offset:1024 nt lds
    buffer_load_dwordx4 v6, s[24:27], s49 offen offset:2048 nt lds
    buffer_load_dwordx4 v7, s[24:27], s49 offen offset:3072 nt lds
    s_add_u32 s45, s45, 8192
    s_add_u32 s47, s47, 8192
    s_and_b32 s47, s47, 0xffff
    s_mov_b32 s44, 0
L_K_lp1:
    s_waitcnt vmcnt(32)
    s_barrier
    s_add_u32 s46, s47, 0
    s_add_u32 m0, s46, 0
    s_add_u32 s49, s45, 0
    buffer_load_dwordx4 v4, s[24:27], s49 offen offset:0 nt lds
    buffer_load_dwordx4 v5, s[24:27], s49 offen offset:1024 nt lds
    buffer_load_dwordx4 v6, s[24:27], s49 offen offset:2048 nt lds
    buffer_load_dwordx4 v7, s[24:27], s49 offen offset:3072 nt lds
    s_add_u32 m0, s46, 4096
    s_add_u32 s49, s45, 4096
    buffer_load_dwordx4 v4, s[24:27], s49 offen offset:0 nt lds
    buffer_load_dwordx4 v5, s[24:27], s49 offen offset:1024 nt lds
    buffer_load_dwordx4 v6, s[24:27], s49 offen offset:2048 nt lds
    buffer_load_dwordx4 v7, s[24:27], s49 offen offset:3072 nt lds
    s_add_u32 s45, s45, 8192
    s_add_u32 s47, s47, 8192
    s_and_b32 s47, s47, 0xffff
    s_add_u32 s44, s44, 1
    s_cmp_lt_u32 s44, 6
    s_cbranch_scc1 L_K_lp1
    s_waitcnt vmcnt(32)
    s_barrier
    s_lshl_b32 s54, s59, 7
    s_add_u32 s54, s54, 0
    s_mov_b32 m0, 0
    s_add_u32 s55, s54, 8192
    buffer_load_dwordx4 v12, s[36:39], s54 offen lds
    buffer_load_dwordx4 v12, s[36:39], s55 offen offset:1024 lds
    s_add_u32 s54, s54, 18432
    s_mov_b32 m0, 2048
    s_add_u32 s55, s54, 8192
    buffer_load_dwordx4 v12, s[36:39], s54 offen lds
    buffer_load_dwordx4 v12, s[36:39], s55 offen offset:1024 lds
    s_add_u32 s54, s54, 18432
    s_mov_b32 m0, 4096
    s_add_u32 s55, s54, 8192
    buffer_load_dwordx4 v12, s[36:39], s54 offen lds
    buffer_load_dwordx4 v12, s[36:39], s55 offen offset:1024 lds
    s_add_u32 s54, s54, 18432
    s_mov_b32 m0, 6144
    s_add_u32 s55, s54, 8192
    buffer_load_dwordx4 v12, s[36:39], s54 offen lds
    buffer_load_dwordx4 v12, s[36:39], s55 offen offset:1024 lds
    s_lshl_b32 s54, s59, 7
    s_add_u32 s54, s54, 73728
    s_mov_b32 m0, 8192
    s_add_u32 s55, s54, 8192
    buffer_load_dwordx4 v12, s[36:39], s54 offen lds
    buffer_load_dwordx4 v12, s[36:39], s55 offen offset:1024 lds
    s_add_u32 s54, s54, 18432
    s_mov_b32 m0, 10240
    s_add_u32 s55, s54, 8192
    buffer_load_dwordx4 v12, s[36:39], s54 offen lds
    buffer_load_dwordx4 v12, s[36:39], s55 offen offset:1024 lds
    s_add_u32 s54, s54, 18432
    s_mov_b32 m0, 12288
    s_add_u32 s55, s54, 8192
    buffer_load_dwordx4 v12, s[36:39], s54 offen lds
    buffer_load_dwordx4 v12, s[36:39], s55 offen offset:1024 lds
    s_add_u32 s54, s54, 18432
    s_mov_b32 m0, 14336
    s_add_u32 s55, s54, 8192
    buffer_load_dwordx4 v12, s[36:39], s54 offen lds
    buffer_load_dwordx4 v12, s[36:39], s55 offen offset:1024 lds
    s_lshl_b32 s54, s59, 7
    s_add_u32 s54, s54, 2359296
    s_mov_b32 m0, 65536
    s_add_u32 s55, s54, 8192
    buffer_load_dwordx4 v12, s[36:39], s54 offen lds
    buffer_load_dwordx4 v12, s[36:39], s55 offen offset:1024 lds
    s_add_u32 s54, s54, 18432
    s_mov_b32 m0, 67584
    s_add_u32 s55, s54, 8192
    buffer_load_dwordx4 v12, s[36:39], s54 offen lds
    buffer_load_dwordx4 v12, s[36:39], s55 offen offset:1024 lds
    s_add_u32 s54, s54, 18432
    s_mov_b32 m0, 69632
    s_add_u32 s55, s54, 8192
    buffer_load_dwordx4 v12, s[36:39], s54 offen lds
    buffer_load_dwordx4 v12, s[36:39], s55 offen offset:1024 lds
    s_add_u32 s54, s54, 18432
    s_mov_b32 m0, 71680
    s_add_u32 s55, s54, 8192
    buffer_load_dwordx4 v12, s[36:39], s54 offen lds
    buffer_load_dwordx4 v12, s[36:39], s55 offen offset:1024 lds
    s_waitcnt vmcnt(48)
    s_barrier
    s_lshl_b32 s54, s59, 7
    s_add_u32 s54, s54, 147456
    s_mov_b32 m0, 16384
    s_add_u32 s55, s54, 8192
    buffer_load_dwordx4 v12, s[36:39], s54 offen lds
    buffer_load_dwordx4 v12, s[36:39], s55 offen offset:1024 lds
    s_add_u32 s54, s54, 18432
    s_mov_b32 m0, 18432
    s_add_u32 s55, s54, 8192
    buffer_load_dwordx4 v12, s[36:39], s54 offen lds
    buffer_load_dwordx4 v12, s[36:39], s55 offen offset:1024 lds
    s_add_u32 s54, s54, 18432
    s_mov_b32 m0, 20480
    s_add_u32 s55, s54, 8192
    buffer_load_dwordx4 v12, s[36:39], s54 offen lds
    buffer_load_dwordx4 v12, s[36:39], s55 offen offset:1024 lds
    s_add_u32 s54, s54, 18432
    s_mov_b32 m0, 22528
    s_add_u32 s55, s54, 8192
    buffer_load_dwordx4 v12, s[36:39], s54 offen lds
    buffer_load_dwordx4 v12, s[36:39], s55 offen offset:1024 lds
    s_lshl_b32 s54, s59, 7
    s_add_u32 s54, s54, 2580480
    s_mov_b32 m0, 90112
    s_add_u32 s55, s54, 8192
    buffer_load_dwordx4 v12, s[36:39], s54 offen lds
    buffer_load_dwordx4 v12, s[36:39], s55 offen offset:1024 lds
    s_add_u32 s54, s54, 18432
    s_mov_b32 m0, 92160
    s_add_u32 s55, s54, 8192
    buffer_load_dwordx4 v12, s[36:39], s54 offen lds
    buffer_load_dwordx4 v12, s[36:39], s55 offen offset:1024 lds
    s_add_u32 s54, s54, 18432
    s_mov_b32 m0, 94208
    s_add_u32 s55, s54, 8192
    buffer_load_dwordx4 v12, s[36:39], s54 offen lds
    buffer_load_dwordx4 v12, s[36:39], s55 offen offset:1024 lds
    s_add_u32 s54, s54, 18432
    s_mov_b32 m0, 96256
    s_add_u32 s55, s54, 8192
    buffer_load_dwordx4 v12, s[36:39], s54 offen lds
    buffer_load_dwordx4 v12, s[36:39], s55 offen offset:1024 lds
    s_waitcnt vmcnt(56)
    s_barrier
    s_lshl_b32 s54, s59, 7
    s_add_u32 s54, s54, 221184
    s_mov_b32 m0, 24576
    s_add_u32 s55, s54, 8192
    buffer_load_dwordx4 v12, s[36:39], s54 offen lds
    buffer_load_dwordx4 v12, s[36:39], s55 offen offset:1024 lds
    s_add_u32 s54, s54, 18432
    s_mov_b32 m0, 26624
    s_add_u32 s55, s54, 8192
    buffer_load_dwordx4 v12, s[36:39], s54 offen lds
    buffer_load_dwordx4 v12, s[36:39], s55 offen offset:1024 lds
    s_add_u32 s54, s54, 18432
    s_mov_b32 m0, 28672
    s_add_u32 s55, s54, 8192
    buffer_load_dwordx4 v12, s[36:39], s54 offen lds
    buffer_load_dwordx4 v12, s[36:39], s55 offen offset:1024 lds
    s_add_u32 s54, s54, 18432
    s_mov_b32 m0, 30720
    s_add_u32 s55, s54, 8192
    buffer_load_dwordx4 v12, s[36:39], s54 offen lds
    buffer_load_dwordx4 v12, s[36:39], s55 offen offset:1024 lds
    s_waitcnt vmcnt(56)
    s_barrier
    s_lshl_b32 s54, s59, 7
    s_add_u32 s54, s54, 1179648
    s_mov_b32 m0, 32768
    s_add_u32 s55, s54, 8192
    buffer_load_dwordx4 v12, s[36:39], s54 offen lds
    buffer_load_dwordx4 v12, s[36:39], s55 offen offset:1024 lds
    s_add_u32 s54, s54, 18432
    s_mov_b32 m0, 34816
    s_add_u32 s55, s54, 8192
    buffer_load_dwordx4 v12, s[36:39], s54 offen lds
    buffer_load_dwordx4 v12, s[36:39], s55 offen offset:1024 lds
    s_add_u32 s54, s54, 18432
    s_mov_b32 m0, 36864
    s_add_u32 s55, s54, 8192
    buffer_load_dwordx4 v12, s[36:39], s54 offen lds
    buffer_load_dwordx4 v12, s[36:39], s55 offen offset:1024 lds
    s_add_u32 s54, s54, 18432
    s_mov_b32 m0, 38912
    s_add_u32 s55, s54, 8192
    buffer_load_dwordx4 v12, s[36:39], s54 offen lds
    buffer_load_dwordx4 v12, s[36:39], s55 offen offset:1024 lds
    s_waitcnt vmcnt(56)
    s_barrier
    s_barrier
    s_waitcnt vmcnt(0)
    s_barrier
    s_barrier
    v_mov_b32 v5, v12
    s_mov_b32 s63, 2
    s_mov_b32 s61, 131072
L_helper1:
    s_mul_i32 s29, s63, 1179648
    s_lshl_b32 s44, s59, 7
    s_add_u32 s29, s29, s44
    s_add_u32 s29, s29, 884736
    s_add_u32 m0, s61, 0
    s_add_u32 s31, s29, 8192
    buffer_load_dwordx4 v5, s[36:39], s29 offen lds
    buffer_load_dwordx4 v5, s[36:39], s31 offen offset:1024 lds
    s_add_u32 s29, s29, 18432
    s_add_u32 m0, s61, 2048
    s_add_u32 s31, s29, 8192
    buffer_load_dwordx4 v5, s[36:39], s29 offen lds
    buffer_load_dwordx4 v5, s[36:39], s31 offen offset:1024 lds
    s_add_u32 s29, s29, 18432
    s_add_u32 m0, s61, 4096
    s_add_u32 s31, s29, 8192
    buffer_load_dwordx4 v5, s[36:39], s29 offen lds
    buffer_load_dwordx4 v5, s[36:39], s31 offen offset:1024 lds
    s_add_u32 s29, s29, 18432
    s_add_u32 m0, s61, 6144
    s_add_u32 s31, s29, 8192
    buffer_load_dwordx4 v5, s[36:39], s29 offen lds
    buffer_load_dwordx4 v5, s[36:39], s31 offen offset:1024 lds
    s_add_u32 s29, s29, 18432
    s_add_u32 m0, s61, 8192
    s_add_u32 s31, s29, 8192
    buffer_load_dwordx4 v5, s[36:39], s29 offen lds
    buffer_load_dwordx4 v5, s[36:39], s31 offen offset:1024 lds
    s_add_u32 s29, s29, 18432
    s_add_u32 m0, s61, 10240
    s_add_u32 s31, s29, 8192
    buffer_load_dwordx4 v5, s[36:39], s29 offen lds
    buffer_load_dwordx4 v5, s[36:39], s31 offen offset:1024 lds
    s_add_u32 s29, s29, 18432
    s_add_u32 m0, s61, 12288
    s_add_u32 s31, s29, 8192
    buffer_load_dwordx4 v5, s[36:39], s29 offen lds
    buffer_load_dwordx4 v5, s[36:39], s31 offen offset:1024 lds
    s_add_u32 s29, s29, 18432
    s_add_u32 m0, s61, 14336
    s_add_u32 s31, s29, 8192
    buffer_load_dwordx4 v5, s[36:39], s29 offen lds
    buffer_load_dwordx4 v5, s[36:39], s31 offen offset:1024 lds
    s_add_u32 s29, s29, 18432
    v_lshrrev_b32 v3, 5, v0
    v_and_b32 v6, 15, v0
    v_lshrrev_b32 v6, 2, v6
    v_lshlrev_b32 v7, 2, v3
    v_add_u32 v7, v7, v6
    v_lshlrev_b32 v7, 7, v7
    v_bfe_u32 v10, v0, 4, 1
    v_lshlrev_b32 v10, 5, v10
    v_add_u32 v7, v7, v10
    v_and_b32 v10, 3, v0
    v_lshlrev_b32 v10, 3, v10
    v_add_u32 v7, v7, v10
    v_add_u32 v7, s61, v7
    v_lshrrev_b32 v6, 1, v6
    v_lshlrev_b32 v6, 6, v6
    v_add_u32 v8, v7, v6
    v_xor_b32 v6, 64, v6
    v_add_u32 v9, v7, v6
    s_mov_b32 s40, s18
    s_mov_b32 s41, s19
    s_mov_b32 s42, 7340032
    s_mov_b32 s43, 0x20000
    v_bfe_u32 v2, v0, 4, 1
    v_lshlrev_b32 v2, 17, v2
    v_lshlrev_b32 v4, 8, v3
    v_add_u32 v2, v2, v4
    v_and_b32 v4, 15, v0
    v_lshlrev_b32 v4, 4, v4
    v_add_u32 v2, v2, v4
    s_lshl_b32 s28, s58, 9
    s_lshl_b32 s44, s63, 6
    s_add_u32 s28, s28, s44
    s_add_u32 s28, s28, 48
    s_lshl_b32 s28, s28, 9
    v_mov_b32 v16, 0
    v_mov_b32 v17, 0
    v_mov_b32 v18, 0
    v_mov_b32 v19, 0
    v_mov_b32 v20, 0
    v_mov_b32 v21, 0
    v_mov_b32 v22, 0
    v_mov_b32 v23, 0
    v_mov_b32 v24, 0
    v_mov_b32 v25, 0
    v_mov_b32 v26, 0
    v_mov_b32 v27, 0
    v_mov_b32 v28, 0
    v_mov_b32 v29, 0
    v_mov_b32 v30, 0
    v_mov_b32 v31, 0
    v_mov_b32 v32, 0
    v_mov_b32 v33, 0
    v_mov_b32 v34, 0
    v_mov_b32 v35, 0
    v_mov_b32 v36, 0
    v_mov_b32 v37, 0
    v_mov_b32 v38, 0
    v_mov_b32 v39, 0
    v_mov_b32 v40, 0
    v_mov_b32 v41, 0
    v_mov_b32 v42, 0
    v_mov_b32 v43, 0
    v_mov_b32 v44, 0
    v_mov_b32 v45, 0
    v_mov_b32 v46, 0
    v_mov_b32 v47, 0
    s_cmp_ge_u32 s2, 252
    s_cbranch_scc1 L_end
    s_mov_b32 s52, s16
    s_mov_b32 s53, s17
    s_mov_b32 s54, 256
    s_mov_b32 s55, 0x20000
    s_mov_b32 s66, 0
    s_mov_b32 s56, 0
L_epochh1:
    s_add_u32 s56, s56, 1
    s_cmp_lg_u32 s66, 0
    s_cbranch_scc1 L_epoch_okh1
    s_cmp_ge_u32 s56, 100000
    s_cbranch_scc1 L_epoch_okh1
    v_mov_b32 v14, 0
    buffer_load_dwordx2 v[12:13], v14, s[52:55], 0 offen offset:128 sc1
    s_waitcnt vmcnt(0)
    v_readfirstlane_b32 s66, v12
    v_readfirstlane_b32 s67, v13
    s_nop 3
    s_branch L_epochh1
L_epoch_okh1:
    s_add_u32 s52, s18, 8388608
    s_addc_u32 s53, s19, 0
    s_mov_b32 s54, 32768
    s_mov_b32 s55, 0x20000
    s_lshl_b32 s24, s58, 1
    s_mul_hi_u32 s25, s24, 613566757
    s_add_u32 s24, s24, 1
    s_mul_hi_u32 s24, s24, 613566757
    s_lshl_b32 s24, s24, 12
    s_lshl_b32 s25, s25, 12
    v_and_b32 v11, 7, v0
    v_lshlrev_b32 v11, 7, v11
    s_lshl_b32 s56, s63, 10
    v_add_u32 v11, s56, v11
    v_and_b32 v14, 8, v0
    v_mov_b32 v12, s25
    v_mov_b32 v13, s24
    v_cmp_eq_u32 vcc, 0, v14
    s_nop 1
    v_cndmask_b32 v12, v13, v12, vcc
    v_add_u32 v11, v11, v12
    s_mov_b32 s56, 0
    s_mov_b64 exec, 0xc0c0
L_pollh1:
    buffer_load_dwordx2 v[12:13], v11, s[52:55], 0 offen sc1
    s_waitcnt vmcnt(0)
    v_cmp_eq_u32 vcc, s66, v12
    v_cmp_eq_u32 s[68:69], s67, v13
    s_nop 1
    s_and_b64 s[68:69], s[68:69], vcc
    s_add_u32 s56, s56, 1
    s_cmp_eq_u64 s[68:69], 0xc0c0
    s_cbranch_scc1 L_polldh1
    s_cmp_ge_u32 s56, 100000
    s_cbranch_scc1 L_polldh1
    s_sleep 1
    s_branch L_pollh1
L_polldh1:
    s_mov_b64 exec, -1
    s_cmp_ge_u32 s2, 252
    s_cbranch_scc1 L_end
    buffer_load_dwordx4 v[48:51], v2, s[40:43], s28 offen sc1
    s_add_u32 s28, s28, 512
    buffer_load_dwordx4 v[52:55], v2, s[40:43], s28 offen sc1
    s_add_u32 s28, s28, 512
    buffer_load_dwordx4 v[56:59], v2, s[40:43], s28 offen sc1
    s_add_u32 s28, s28, 512
    buffer_load_dwordx4 v[60:63], v2, s[40:43], s28 offen sc1
    s_add_u32 s28, s28, 512
    buffer_load_dwordx4 v[64:67], v2, s[40:43], s28 offen sc1
    s_add_u32 s28, s28, 512
    buffer_load_dwordx4 v[68:71], v2, s[40:43], s28 offen sc1
    s_add_u32 s28, s28, 512
    buffer_load_dwordx4 v[72:75], v2, s[40:43], s28 offen sc1
    s_add_u32 s28, s28, 512
    buffer_load_dwordx4 v[76:79], v2, s[40:43], s28 offen sc1
    s_add_u32 s28, s28, 512
    buffer_load_dwordx4 v[80:83], v2, s[40:43], s28 offen sc1
    s_add_u32 s28, s28, 512
    buffer_load_dwordx4 v[84:87], v2, s[40:43], s28 offen sc1
    s_add_u32 s28, s28, 512
    buffer_load_dwordx4 v[88:91], v2, s[40:43], s28 offen sc1
    s_add_u32 s28, s28, 512
    buffer_load_dwordx4 v[92:95], v2, s[40:43], s28 offen sc1
    s_add_u32 s28, s28, 512
    buffer_load_dwordx4 v[96:99], v2, s[40:43], s28 offen sc1
    s_add_u32 s28, s28, 512
    buffer_load_dwordx4 v[100:103], v2, s[40:43], s28 offen sc1
    s_add_u32 s28, s28, 512
    buffer_load_dwordx4 v[104:107], v2, s[40:43], s28 offen sc1
    s_add_u32 s28, s28, 512
    buffer_load_dwordx4 v[108:111], v2, s[40:43], s28 offen sc1
    s_add_u32 s28, s28, 512
    s_waitcnt vmcnt(30)
    ds_read_b64_tr_b16 a[0:1], v8 offset:0
    ds_read_b64_tr_b16 a[2:3], v8 offset:1024
    ds_read_b64_tr_b16 a[4:5], v9 offset:0
    ds_read_b64_tr_b16 a[6:7], v9 offset:1024
    s_waitcnt vmcnt(28)
    ds_read_b64_tr_b16 a[8:9], v8 offset:2048
    ds_read_b64_tr_b16 a[10:11], v8 offset:3072
    ds_read_b64_tr_b16 a[12:13], v9 offset:2048
    ds_read_b64_tr_b16 a[14:15], v9 offset:3072
    s_waitcnt vmcnt(26)
    ds_read_b64_tr_b16 a[16:17], v8 offset:4096
    ds_read_b64_tr_b16 a[18:19], v8 offset:5120
    ds_read_b64_tr_b16 a[20:21], v9 offset:4096
    ds_read_b64_tr_b16 a[22:23], v9 offset:5120
    s_waitcnt vmcnt(24)
    ds_read_b64_tr_b16 a[24:25], v8 offset:6144
    ds_read_b64_tr_b16 a[26:27], v8 offset:7168
    ds_read_b64_tr_b16 a[28:29], v9 offset:6144
    ds_read_b64_tr_b16 a[30:31], v9 offset:7168
    s_waitcnt vmcnt(22)
    ds_read_b64_tr_b16 a[32:33], v8 offset:8192
    ds_read_b64_tr_b16 a[34:35], v8 offset:9216
    ds_read_b64_tr_b16 a[36:37], v9 offset:8192
    ds_read_b64_tr_b16 a[38:39], v9 offset:9216
    s_waitcnt vmcnt(20)
    ds_read_b64_tr_b16 a[40:41], v8 offset:10240
    ds_read_b64_tr_b16 a[42:43], v8 offset:11264
    ds_read_b64_tr_b16 a[44:45], v9 offset:10240
    ds_read_b64_tr_b16 a[46:47], v9 offset:11264
    s_waitcnt vmcnt(18)
    ds_read_b64_tr_b16 a[48:49], v8 offset:12288
    ds_read_b64_tr_b16 a[50:51], v8 offset:13312
    ds_read_b64_tr_b16 a[52:53], v9 offset:12288
    ds_read_b64_tr_b16 a[54:55], v9 offset:13312
    s_waitcnt vmcnt(16)
    ds_read_b64_tr_b16 a[56:57], v8 offset:14336
    ds_read_b64_tr_b16 a[58:59], v8 offset:15360
    ds_read_b64_tr_b16 a[60:61], v9 offset:14336
    ds_read_b64_tr_b16 a[62:63], v9 offset:15360
    s_waitcnt lgkmcnt(0)
    s_add_u32 m0, s61, 0
    s_add_u32 s31, s29, 8192
    buffer_load_dwordx4 v5, s[36:39], s29 offen lds
    buffer_load_dwordx4 v5, s[36:39], s31 offen offset:1024 lds
    s_add_u32 s29, s29, 18432
    s_add_u32 m0, s61, 2048
    s_add_u32 s31, s29, 8192
    buffer_load_dwordx4 v5, s[36:39], s29 offen lds
    buffer_load_dwordx4 v5, s[36:39], s31 offen offset:1024 lds
    s_add_u32 s29, s29, 18432
    s_add_u32 m0, s61, 4096
    s_add_u32 s31, s29, 8192
    buffer_load_dwordx4 v5, s[36:39], s29 offen lds
    buffer_load_dwordx4 v5, s[36:39], s31 offen offset:1024 lds
    s_add_u32 s29, s29, 18432
    s_add_u32 m0, s61, 6144
    s_add_u32 s31, s29, 8192
    buffer_load_dwordx4 v5, s[36:39], s29 offen lds
    buffer_load_dwordx4 v5, s[36:39], s31 offen offset:1024 lds
    s_add_u32 s29, s29, 18432
    s_add_u32 m0, s61, 8192
    s_add_u32 s31, s29, 8192
    buffer_load_dwordx4 v5, s[36:39], s29 offen lds
    buffer_load_dwordx4 v5, s[36:39], s31 offen offset:1024 lds
    s_add_u32 s29, s29, 18432
    s_add_u32 m0, s61, 10240
    s_add_u32 s31, s29, 8192
    buffer_load_dwordx4 v5, s[36:39], s29 offen lds
    buffer_load_dwordx4 v5, s[36:39], s31 offen offset:1024 lds
    s_add_u32 s29, s29, 18432
    s_add_u32 m0, s61, 12288
    s_add_u32 s31, s29, 8192
    buffer_load_dwordx4 v5, s[36:39], s29 offen lds
    buffer_load_dwordx4 v5, s[36:39], s31 offen offset:1024 lds
    s_add_u32 s29, s29, 18432
    s_add_u32 m0, s61, 14336
    s_add_u32 s31, s29, 8192
    buffer_load_dwordx4 v5, s[36:39], s29 offen lds
    buffer_load_dwordx4 v5, s[36:39], s31 offen offset:1024 lds
    s_add_u32 s29, s29, 18432
    s_waitcnt vmcnt(14)
    ds_read_b64_tr_b16 v[128:129], v8 offset:0
    ds_read_b64_tr_b16 v[130:131], v8 offset:1024
    ds_read_b64_tr_b16 v[132:133], v9 offset:0
    ds_read_b64_tr_b16 v[134:135], v9 offset:1024
    s_waitcnt vmcnt(12)
    ds_read_b64_tr_b16 v[136:137], v8 offset:2048
    ds_read_b64_tr_b16 v[138:139], v8 offset:3072
    ds_read_b64_tr_b16 v[140:141], v9 offset:2048
    ds_read_b64_tr_b16 v[142:143], v9 offset:3072
    s_waitcnt vmcnt(10)
    ds_read_b64_tr_b16 v[144:145], v8 offset:4096
    ds_read_b64_tr_b16 v[146:147], v8 offset:5120
    ds_read_b64_tr_b16 v[148:149], v9 offset:4096
    ds_read_b64_tr_b16 v[150:151], v9 offset:5120
    s_waitcnt vmcnt(8)
    ds_read_b64_tr_b16 v[152:153], v8 offset:6144
    ds_read_b64_tr_b16 v[154:155], v8 offset:7168
    ds_read_b64_tr_b16 v[156:157], v9 offset:6144
    ds_read_b64_tr_b16 v[158:159], v9 offset:7168
    s_waitcnt vmcnt(6)
    ds_read_b64_tr_b16 v[160:161], v8 offset:8192
    ds_read_b64_tr_b16 v[162:163], v8 offset:9216
    ds_read_b64_tr_b16 v[164:165], v9 offset:8192
    ds_read_b64_tr_b16 v[166:167], v9 offset:9216
    s_waitcnt vmcnt(4)
    ds_read_b64_tr_b16 v[168:169], v8 offset:10240
    ds_read_b64_tr_b16 v[170:171], v8 offset:11264
    ds_read_b64_tr_b16 v[172:173], v9 offset:10240
    ds_read_b64_tr_b16 v[174:175], v9 offset:11264
    s_waitcnt vmcnt(2)
    ds_read_b64_tr_b16 v[176:177], v8 offset:12288
    ds_read_b64_tr_b16 v[178:179], v8 offset:13312
    ds_read_b64_tr_b16 v[180:181], v9 offset:12288
    ds_read_b64_tr_b16 v[182:183], v9 offset:13312
    s_waitcnt vmcnt(0)
    ds_read_b64_tr_b16 v[184:185], v8 offset:14336
    ds_read_b64_tr_b16 v[186:187], v8 offset:15360
    ds_read_b64_tr_b16 v[188:189], v9 offset:14336
    ds_read_b64_tr_b16 v[190:191], v9 offset:15360
    s_waitcnt lgkmcnt(0)
    s_waitcnt vmcnt(31)
    v_mfma_f32_32x32x16_bf16 v[16:31], a[0:3], v[48:51], v[16:31]
    v_mfma_f32_32x32x16_bf16 v[32:47], a[4:7], v[48:51], v[32:47]
    s_waitcnt vmcnt(30)
    v_mfma_f32_32x32x16_bf16 v[16:31], a[8:11], v[52:55], v[16:31]
    v_mfma_f32_32x32x16_bf16 v[32:47], a[12:15], v[52:55], v[32:47]
    s_waitcnt vmcnt(29)
    v_mfma_f32_32x32x16_bf16 v[16:31], a[16:19], v[56:59], v[16:31]
    v_mfma_f32_32x32x16_bf16 v[32:47], a[20:23], v[56:59], v[32:47]
    s_waitcnt vmcnt(28)
    v_mfma_f32_32x32x16_bf16 v[16:31], a[24:27], v[60:63], v[16:31]
    v_mfma_f32_32x32x16_bf16 v[32:47], a[28:31], v[60:63], v[32:47]
    s_waitcnt vmcnt(27)
    v_mfma_f32_32x32x16_bf16 v[16:31], a[32:35], v[64:67], v[16:31]
    v_mfma_f32_32x32x16_bf16 v[32:47], a[36:39], v[64:67], v[32:47]
    s_waitcnt vmcnt(26)
    v_mfma_f32_32x32x16_bf16 v[16:31], a[40:43], v[68:71], v[16:31]
    v_mfma_f32_32x32x16_bf16 v[32:47], a[44:47], v[68:71], v[32:47]
    s_waitcnt vmcnt(25)
    v_mfma_f32_32x32x16_bf16 v[16:31], a[48:51], v[72:75], v[16:31]
    v_mfma_f32_32x32x16_bf16 v[32:47], a[52:55], v[72:75], v[32:47]
    s_waitcnt vmcnt(24)
    v_mfma_f32_32x32x16_bf16 v[16:31], a[56:59], v[76:79], v[16:31]
    v_mfma_f32_32x32x16_bf16 v[32:47], a[60:63], v[76:79], v[32:47]
    s_waitcnt vmcnt(23)
    v_mfma_f32_32x32x16_bf16 v[16:31], v[128:131], v[80:83], v[16:31]
    v_mfma_f32_32x32x16_bf16 v[32:47], v[132:135], v[80:83], v[32:47]
    s_waitcnt vmcnt(22)
    v_mfma_f32_32x32x16_bf16 v[16:31], v[136:139], v[84:87], v[16:31]
    v_mfma_f32_32x32x16_bf16 v[32:47], v[140:143], v[84:87], v[32:47]
    s_waitcnt vmcnt(21)
    v_mfma_f32_32x32x16_bf16 v[16:31], v[144:147], v[88:91], v[16:31]
    v_mfma_f32_32x32x16_bf16 v[32:47], v[148:151], v[88:91], v[32:47]
    s_waitcnt vmcnt(20)
    v_mfma_f32_32x32x16_bf16 v[16:31], v[152:155], v[92:95], v[16:31]
    v_mfma_f32_32x32x16_bf16 v[32:47], v[156:159], v[92:95], v[32:47]
    s_waitcnt vmcnt(19)
    v_mfma_f32_32x32x16_bf16 v[16:31], v[160:163], v[96:99], v[16:31]
    v_mfma_f32_32x32x16_bf16 v[32:47], v[164:167], v[96:99], v[32:47]
    s_waitcnt vmcnt(18)
    v_mfma_f32_32x32x16_bf16 v[16:31], v[168:171], v[100:103], v[16:31]
    v_mfma_f32_32x32x16_bf16 v[32:47], v[172:175], v[100:103], v[32:47]
    s_waitcnt vmcnt(17)
    v_mfma_f32_32x32x16_bf16 v[16:31], v[176:179], v[104:107], v[16:31]
    v_mfma_f32_32x32x16_bf16 v[32:47], v[180:183], v[104:107], v[32:47]
    s_waitcnt vmcnt(16)
    v_mfma_f32_32x32x16_bf16 v[16:31], v[184:187], v[108:111], v[16:31]
    v_mfma_f32_32x32x16_bf16 v[32:47], v[188:191], v[108:111], v[32:47]
    s_nop 7
    s_nop 7
    s_barrier
    v_lshlrev_b32 v10, 4, v0
    s_lshl_b32 s24, s63, 13
    s_add_u32 s24, s24, 131072
    v_add_u32 v11, s24, v10
    ds_write_b128 v11, v[16:19] offset:0
    ds_write_b128 v11, v[20:23] offset:1024
    ds_write_b128 v11, v[24:27] offset:2048
    ds_write_b128 v11, v[28:31] offset:3072
    ds_write_b128 v11, v[32:35] offset:4096
    ds_write_b128 v11, v[36:39] offset:5120
    ds_write_b128 v11, v[40:43] offset:6144
    ds_write_b128 v11, v[44:47] offset:7168
    s_waitcnt lgkmcnt(0)
    s_barrier
    s_endpgm
L_prodV:
    s_and_b32 s28, s2, 7
    s_lshr_b32 s29, s2, 3
    s_and_b32 s30, s28, 3
    s_lshr_b32 s28, s28, 2
    s_lshl_b32 s28, s28, 5
    s_add_u32 s29, s29, s28
    s_mul_hi_u32 s59, s29, 613566757
    s_mul_i32 s28, s59, 7
    s_sub_u32 s28, s29, s28
    s_mul_i32 s58, s30, 7
    s_add_u32 s58, s58, s28
    s_mov_b32 s57, 0
    v_lshrrev_b32 v12, 3, v0
    s_mov_b32 s24, 1152
    v_mul_lo_u32 v12, v12, s24
    v_bfe_u32 v10, v0, 4, 1
    v_lshlrev_b32 v10, 2, v10
    v_and_b32 v11, 7, v0
    v_xor_b32 v10, v10, v11
    v_lshlrev_b32 v10, 4, v10
    v_add_u32 v12, v12, v10
    v_lshlrev_b32 v8, 8, v1
    v_lshlrev_b32 v3, 2, v1
    v_xor_b32 v3, v3, v2
    v_lshlrev_b32 v3, 4, v3
    v_add_u32 v4, v3, v8
    s_lshl_b32 s24, s20, 4
    s_add_u32 s24, s24, s22
    s_lshl_b32 s24, s24, 18
    s_mul_i32 s50, s59, 128
    s_add_u32 s50, s50, 2064384
    s_mov_b32 s51, 81920
    s_waitcnt lgkmcnt(0)
    s_add_u32 s24, s8, s24
    s_addc_u32 s25, s9, 0
    s_mov_b32 s26, 262144
    s_mov_b32 s27, 0x20000
    s_mov_b32 s36, s12
    s_mov_b32 s37, s13
    s_mov_b32 s38, 4718592
    s_mov_b32 s39, 0x20000
    s_mov_b32 s45, 0
    s_mov_b32 s47, 0
    s_barrier
    s_barrier
    s_add_u32 s46, s47, 98304
    s_add_u32 m0, s46, 0
    s_add_u32 s49, s45, 0
    buffer_load_dwordx4 v4, s[24:27], s49 offen offset:0 nt lds
    buffer_load_dwordx4 v4, s[24:27], s49 offen offset:1024 nt lds
    buffer_load_dwordx4 v4, s[24:27], s49 offen offset:2048 nt lds
    buffer_load_dwordx4 v4, s[24:27], s49 offen offset:3072 nt lds
    s_add_u32 m0, s46, 4096
    s_add_u32 s49, s45, 4096
    buffer_load_dwordx4 v4, s[24:27], s49 offen offset:0 nt lds
    buffer_load_dwordx4 v4, s[24:27], s49 offen offset:1024 nt lds
    buffer_load_dwordx4 v4, s[24:27], s49 offen offset:2048 nt lds
    buffer_load_dwordx4 v4, s[24:27], s49 offen offset:3072 nt lds
    s_add_u32 s45, s45, 8192
    s_add_u32 s47, s47, 8192
    s_and_b32 s47, s47, 0xffff
    s_barrier
    s_barrier
    s_barrier
    s_barrier
    s_add_u32 s46, s47, 98304
    s_add_u32 m0, s46, 0
    s_add_u32 s49, s45, 0
    buffer_load_dwordx4 v4, s[24:27], s49 offen offset:0 nt lds
    buffer_load_dwordx4 v4, s[24:27], s49 offen offset:1024 nt lds
    buffer_load_dwordx4 v4, s[24:27], s49 offen offset:2048 nt lds
    buffer_load_dwordx4 v4, s[24:27], s49 offen offset:3072 nt lds
    s_add_u32 m0, s46, 4096
    s_add_u32 s49, s45, 4096
    buffer_load_dwordx4 v4, s[24:27], s49 offen offset:0 nt lds
    buffer_load_dwordx4 v4, s[24:27], s49 offen offset:1024 nt lds
    buffer_load_dwordx4 v4, s[24:27], s49 offen offset:2048 nt lds
    buffer_load_dwordx4 v4, s[24:27], s49 offen offset:3072 nt lds
    s_add_u32 s45, s45, 8192
    s_add_u32 s47, s47, 8192
    s_and_b32 s47, s47, 0xffff
    s_barrier
    s_add_u32 s46, s47, 98304
    s_add_u32 m0, s46, 0
    s_add_u32 s49, s45, 0
    buffer_load_dwordx4 v4, s[24:27], s49 offen offset:0 nt lds
    buffer_load_dwordx4 v4, s[24:27], s49 offen offset:1024 nt lds
    buffer_load_dwordx4 v4, s[24:27], s49 offen offset:2048 nt lds
    buffer_load_dwordx4 v4, s[24:27], s49 offen offset:3072 nt lds
    s_add_u32 m0, s46, 4096
    s_add_u32 s49, s45, 4096
    buffer_load_dwordx4 v4, s[24:27], s49 offen offset:0 nt lds
    buffer_load_dwordx4 v4, s[24:27], s49 offen offset:1024 nt lds
    buffer_load_dwordx4 v4, s[24:27], s49 offen offset:2048 nt lds
    buffer_load_dwordx4 v4, s[24:27], s49 offen offset:3072 nt lds
    s_add_u32 s45, s45, 8192
    s_add_u32 s47, s47, 8192
    s_and_b32 s47, s47, 0xffff
    s_barrier
    s_add_u32 s46, s47, 98304
    s_add_u32 m0, s46, 0
    s_add_u32 s49, s45, 0
    buffer_load_dwordx4 v4, s[24:27], s49 offen offset:0 nt lds
    buffer_load_dwordx4 v4, s[24:27], s49 offen offset:1024 nt lds
    buffer_load_dwordx4 v4, s[24:27], s49 offen offset:2048 nt lds
    buffer_load_dwordx4 v4, s[24:27], s49 offen offset:3072 nt lds
    s_add_u32 m0, s46, 4096
    s_add_u32 s49, s45, 4096
    buffer_load_dwordx4 v4, s[24:27], s49 offen offset:0 nt lds
    buffer_load_dwordx4 v4, s[24:27], s49 offen offset:1024 nt lds
    buffer_load_dwordx4 v4, s[24:27], s49 offen offset:2048 nt lds
    buffer_load_dwordx4 v4, s[24:27], s49 offen offset:3072 nt lds
    s_add_u32 s45, s45, 8192
    s_add_u32 s47, s47, 8192
    s_and_b32 s47, s47, 0xffff
    s_barrier
    s_add_u32 s46, s47, 98304
    s_add_u32 m0, s46, 0
    s_add_u32 s49, s45, 0
    buffer_load_dwordx4 v4, s[24:27], s49 offen offset:0 nt lds
    buffer_load_dwordx4 v4, s[24:27], s49 offen offset:1024 nt lds
    buffer_load_dwordx4 v4, s[24:27], s49 offen offset:2048 nt lds
    buffer_load_dwordx4 v4, s[24:27], s49 offen offset:3072 nt lds
    s_add_u32 m0, s46, 4096
    s_add_u32 s49, s45, 4096
    buffer_load_dwordx4 v4, s[24:27], s49 offen offset:0 nt lds
    buffer_load_dwordx4 v4, s[24:27], s49 offen offset:1024 nt lds
    buffer_load_dwordx4 v4, s[24:27], s49 offen offset:2048 nt lds
    buffer_load_dwordx4 v4, s[24:27], s49 offen offset:3072 nt lds
    s_add_u32 s45, s45, 8192
    s_add_u32 s47, s47, 8192
    s_and_b32 s47, s47, 0xffff
    s_barrier
    s_add_u32 s46, s47, 98304
    s_add_u32 m0, s46, 0
    s_add_u32 s49, s45, 0
    buffer_load_dwordx4 v4, s[24:27], s49 offen offset:0 nt lds
    buffer_load_dwordx4 v4, s[24:27], s49 offen offset:1024 nt lds
    buffer_load_dwordx4 v4, s[24:27], s49 offen offset:2048 nt lds
    buffer_load_dwordx4 v4, s[24:27], s49 offen offset:3072 nt lds
    s_add_u32 m0, s46, 4096
    s_add_u32 s49, s45, 4096
    buffer_load_dwordx4 v4, s[24:27], s49 offen offset:0 nt lds
    buffer_load_dwordx4 v4, s[24:27], s49 offen offset:1024 nt lds
    buffer_load_dwordx4 v4, s[24:27], s49 offen offset:2048 nt lds
    buffer_load_dwordx4 v4, s[24:27], s49 offen offset:3072 nt lds
    s_add_u32 s45, s45, 8192
    s_add_u32 s47, s47, 8192
    s_and_b32 s47, s47, 0xffff
    s_mov_b32 m0, s51
    s_add_u32 s49, s50, 8192
    buffer_load_dwordx4 v12, s[36:39], s50 offen lds
    buffer_load_dwordx4 v12, s[36:39], s49 offen offset:1024 lds
    s_add_u32 s50, s50, 18432
    s_add_u32 s51, s51, 2048
    s_cmp_eq_u32 s51, 98304
    s_cselect_b32 s51, 81920, s51
    s_waitcnt vmcnt(42)
    s_barrier
    s_add_u32 s46, s47, 98304
    s_add_u32 m0, s46, 0
    s_add_u32 s49, s45, 0
    buffer_load_dwordx4 v4, s[24:27], s49 offen offset:0 nt lds
    buffer_load_dwordx4 v4, s[24:27], s49 offen offset:1024 nt lds
    buffer_load_dwordx4 v4, s[24:27], s49 offen offset:2048 nt lds
    buffer_load_dwordx4 v4, s[24:27], s49 offen offset:3072 nt lds
    s_add_u32 m0, s46, 4096
    s_add_u32 s49, s45, 4096
    buffer_load_dwordx4 v4, s[24:27], s49 offen offset:0 nt lds
    buffer_load_dwordx4 v4, s[24:27], s49 offen offset:1024 nt lds
    buffer_load_dwordx4 v4, s[24:27], s49 offen offset:2048 nt lds
    buffer_load_dwordx4 v4, s[24:27], s49 offen offset:3072 nt lds
    s_add_u32 s45, s45, 8192
    s_add_u32 s47, s47, 8192
    s_and_b32 s47, s47, 0xffff
    s_mov_b32 m0, s51
    s_add_u32 s49, s50, 8192
    buffer_load_dwordx4 v12, s[36:39], s50 offen lds
    buffer_load_dwordx4 v12, s[36:39], s49 offen offset:1024 lds
    s_add_u32 s50, s50, 18432
    s_add_u32 s51, s51, 2048
    s_cmp_eq_u32 s51, 98304
    s_cselect_b32 s51, 81920, s51
    s_waitcnt vmcnt(44)
    s_barrier
    s_add_u32 s46, s47, 98304
    s_add_u32 m0, s46, 0
    s_add_u32 s49, s45, 0
    buffer_load_dwordx4 v4, s[24:27], s49 offen offset:0 nt lds
    buffer_load_dwordx4 v4, s[24:27], s49 offen offset:1024 nt lds
    buffer_load_dwordx4 v4, s[24:27], s49 offen offset:2048 nt lds
    buffer_load_dwordx4 v4, s[24:27], s49 offen offset:3072 nt lds
    s_add_u32 m0, s46, 4096
    s_add_u32 s49, s45, 4096
    buffer_load_dwordx4 v4, s[24:27], s49 offen offset:0 nt lds
    buffer_load_dwordx4 v4, s[24:27], s49 offen offset:1024 nt lds
    buffer_load_dwordx4 v4, s[24:27], s49 offen offset:2048 nt lds
    buffer_load_dwordx4 v4, s[24:27], s49 offen offset:3072 nt lds
    s_add_u32 s45, s45, 8192
    s_add_u32 s47, s47, 8192
    s_and_b32 s47, s47, 0xffff
    s_mov_b32 m0, s51
    s_add_u32 s49, s50, 8192
    buffer_load_dwordx4 v12, s[36:39], s50 offen lds
    buffer_load_dwordx4 v12, s[36:39], s49 offen offset:1024 lds
    s_add_u32 s50, s50, 18432
    s_add_u32 s51, s51, 2048
    s_cmp_eq_u32 s51, 98304
    s_cselect_b32 s51, 81920, s51
    s_waitcnt vmcnt(46)
    s_barrier
    s_add_u32 s46, s47, 98304
    s_add_u32 m0, s46, 0
    s_add_u32 s49, s45, 0
    buffer_load_dwordx4 v4, s[24:27], s49 offen offset:0 nt lds
    buffer_load_dwordx4 v4, s[24:27], s49 offen offset:1024 nt lds
    buffer_load_dwordx4 v4, s[24:27], s49 offen offset:2048 nt lds
    buffer_load_dwordx4 v4, s[24:27], s49 offen offset:3072 nt lds
    s_add_u32 m0, s46, 4096
    s_add_u32 s49, s45, 4096
    buffer_load_dwordx4 v4, s[24:27], s49 offen offset:0 nt lds
    buffer_load_dwordx4 v4, s[24:27], s49 offen offset:1024 nt lds
    buffer_load_dwordx4 v4, s[24:27], s49 offen offset:2048 nt lds
    buffer_load_dwordx4 v4, s[24:27], s49 offen offset:3072 nt lds
    s_add_u32 s45, s45, 8192
    s_add_u32 s47, s47, 8192
    s_and_b32 s47, s47, 0xffff
    s_mov_b32 m0, s51
    s_add_u32 s49, s50, 8192
    buffer_load_dwordx4 v12, s[36:39], s50 offen lds
    buffer_load_dwordx4 v12, s[36:39], s49 offen offset:1024 lds
    s_add_u32 s50, s50, 18432
    s_add_u32 s51, s51, 2048
    s_cmp_eq_u32 s51, 98304
    s_cselect_b32 s51, 81920, s51
    s_waitcnt vmcnt(48)
    s_barrier
    s_add_u32 s46, s47, 98304
    s_add_u32 m0, s46, 0
    s_add_u32 s49, s45, 0
    buffer_load_dwordx4 v4, s[24:27], s49 offen offset:0 nt lds
    buffer_load_dwordx4 v4, s[24:27], s49 offen offset:1024 nt lds
    buffer_load_dwordx4 v4, s[24:27], s49 offen offset:2048 nt lds
    buffer_load_dwordx4 v4, s[24:27], s49 offen offset:3072 nt lds
    s_add_u32 m0, s46, 4096
    s_add_u32 s49, s45, 4096
    buffer_load_dwordx4 v4, s[24:27], s49 offen offset:0 nt lds
    buffer_load_dwordx4 v4, s[24:27], s49 offen offset:1024 nt lds
    buffer_load_dwordx4 v4, s[24:27], s49 offen offset:2048 nt lds
    buffer_load_dwordx4 v4, s[24:27], s49 offen offset:3072 nt lds
    s_add_u32 s45, s45, 8192
    s_add_u32 s47, s47, 8192
    s_and_b32 s47, s47, 0xffff
    s_mov_b32 m0, s51
    s_add_u32 s49, s50, 8192
    buffer_load_dwordx4 v12, s[36:39], s50 offen lds
    buffer_load_dwordx4 v12, s[36:39], s49 offen offset:1024 lds
    s_add_u32 s50, s50, 18432
    s_add_u32 s51, s51, 2048
    s_cmp_eq_u32 s51, 98304
    s_cselect_b32 s51, 81920, s51
    s_waitcnt vmcnt(50)
    s_barrier
    s_add_u32 s46, s47, 98304
    s_add_u32 m0, s46, 0
    s_add_u32 s49, s45, 0
    buffer_load_dwordx4 v4, s[24:27], s49 offen offset:0 nt lds
    buffer_load_dwordx4 v4, s[24:27], s49 offen offset:1024 nt lds
    buffer_load_dwordx4 v4, s[24:27], s49 offen offset:2048 nt lds
    buffer_load_dwordx4 v4, s[24:27], s49 offen offset:3072 nt lds
    s_add_u32 m0, s46, 4096
    s_add_u32 s49, s45, 4096
    buffer_load_dwordx4 v4, s[24:27], s49 offen offset:0 nt lds
    buffer_load_dwordx4 v4, s[24:27], s49 offen offset:1024 nt lds
    buffer_load_dwordx4 v4, s[24:27], s49 offen offset:2048 nt lds
    buffer_load_dwordx4 v4, s[24:27], s49 offen offset:3072 nt lds
    s_add_u32 s45, s45, 8192
    s_add_u32 s47, s47, 8192
    s_and_b32 s47, s47, 0xffff
    s_mov_b32 m0, s51
    s_add_u32 s49, s50, 8192
    buffer_load_dwordx4 v12, s[36:39], s50 offen lds
    buffer_load_dwordx4 v12, s[36:39], s49 offen offset:1024 lds
    s_add_u32 s50, s50, 18432
    s_add_u32 s51, s51, 2048
    s_cmp_eq_u32 s51, 98304
    s_cselect_b32 s51, 81920, s51
    s_mov_b32 s44, 0
L_V_lp0:
    s_waitcnt vmcnt(52)
    s_barrier
    s_add_u32 s46, s47, 98304
    s_add_u32 m0, s46, 0
    s_add_u32 s49, s45, 0
    buffer_load_dwordx4 v4, s[24:27], s49 offen offset:0 nt lds
    buffer_load_dwordx4 v4, s[24:27], s49 offen offset:1024 nt lds
    buffer_load_dwordx4 v4, s[24:27], s49 offen offset:2048 nt lds
    buffer_load_dwordx4 v4, s[24:27], s49 offen offset:3072 nt lds
    s_add_u32 m0, s46, 4096
    s_add_u32 s49, s45, 4096
    buffer_load_dwordx4 v4, s[24:27], s49 offen offset:0 nt lds
    buffer_load_dwordx4 v4, s[24:27], s49 offen offset:1024 nt lds
    buffer_load_dwordx4 v4, s[24:27], s49 offen offset:2048 nt lds
    buffer_load_dwordx4 v4, s[24:27], s49 offen offset:3072 nt lds
    s_add_u32 s45, s45, 8192
    s_add_u32 s47, s47, 8192
    s_and_b32 s47, s47, 0xffff
    s_mov_b32 m0, s51
    s_add_u32 s49, s50, 8192
    buffer_load_dwordx4 v12, s[36:39], s50 offen lds
    buffer_load_dwordx4 v12, s[36:39], s49 offen offset:1024 lds
    s_add_u32 s50, s50, 18432
    s_add_u32 s51, s51, 2048
    s_cmp_eq_u32 s51, 98304
    s_cselect_b32 s51, 81920, s51
    s_add_u32 s44, s44, 1
    s_cmp_lt_u32 s44, 10
    s_cbranch_scc1 L_V_lp0
    s_waitcnt vmcnt(52)
    s_barrier
    s_add_u32 s46, s47, 98304
    s_add_u32 m0, s46, 0
    s_add_u32 s49, s45, 0
    buffer_load_dwordx4 v4, s[24:27], s49 offen offset:0 nt lds
    buffer_load_dwordx4 v4, s[24:27], s49 offen offset:1024 nt lds
    buffer_load_dwordx4 v4, s[24:27], s49 offen offset:2048 nt lds
    buffer_load_dwordx4 v4, s[24:27], s49 offen offset:3072 nt lds
    s_add_u32 m0, s46, 4096
    s_add_u32 s49, s45, 4096
    buffer_load_dwordx4 v4, s[24:27], s49 offen offset:0 nt lds
    buffer_load_dwordx4 v4, s[24:27], s49 offen offset:1024 nt lds
    buffer_load_dwordx4 v4, s[24:27], s49 offen offset:2048 nt lds
    buffer_load_dwordx4 v4, s[24:27], s49 offen offset:3072 nt lds
    s_add_u32 s45, s45, 8192
    s_add_u32 s47, s47, 8192
    s_and_b32 s47, s47, 0xffff
    s_waitcnt vmcnt(50)
    s_barrier
    s_add_u32 s46, s47, 98304
    s_add_u32 m0, s46, 0
    s_add_u32 s49, s45, 0
    buffer_load_dwordx4 v4, s[24:27], s49 offen offset:0 nt lds
    buffer_load_dwordx4 v4, s[24:27], s49 offen offset:1024 nt lds
    buffer_load_dwordx4 v4, s[24:27], s49 offen offset:2048 nt lds
    buffer_load_dwordx4 v4, s[24:27], s49 offen offset:3072 nt lds
    s_add_u32 m0, s46, 4096
    s_add_u32 s49, s45, 4096
    buffer_load_dwordx4 v4, s[24:27], s49 offen offset:0 nt lds
    buffer_load_dwordx4 v4, s[24:27], s49 offen offset:1024 nt lds
    buffer_load_dwordx4 v4, s[24:27], s49 offen offset:2048 nt lds
    buffer_load_dwordx4 v4, s[24:27], s49 offen offset:3072 nt lds
    s_add_u32 s45, s45, 8192
    s_add_u32 s47, s47, 8192
    s_and_b32 s47, s47, 0xffff
    s_waitcnt vmcnt(48)
    s_barrier
    s_add_u32 s46, s47, 98304
    s_add_u32 m0, s46, 0
    s_add_u32 s49, s45, 0
    buffer_load_dwordx4 v4, s[24:27], s49 offen offset:0 nt lds
    buffer_load_dwordx4 v4, s[24:27], s49 offen offset:1024 nt lds
    buffer_load_dwordx4 v4, s[24:27], s49 offen offset:2048 nt lds
    buffer_load_dwordx4 v4, s[24:27], s49 offen offset:3072 nt lds
    s_add_u32 m0, s46, 4096
    s_add_u32 s49, s45, 4096
    buffer_load_dwordx4 v4, s[24:27], s49 offen offset:0 nt lds
    buffer_load_dwordx4 v4, s[24:27], s49 offen offset:1024 nt lds
    buffer_load_dwordx4 v4, s[24:27], s49 offen offset:2048 nt lds
    buffer_load_dwordx4 v4, s[24:27], s49 offen offset:3072 nt lds
    s_add_u32 s45, s45, 8192
    s_add_u32 s47, s47, 8192
    s_and_b32 s47, s47, 0xffff
    s_waitcnt vmcnt(46)
    s_barrier
    s_add_u32 s46, s47, 98304
    s_add_u32 m0, s46, 0
    s_add_u32 s49, s45, 0
    buffer_load_dwordx4 v4, s[24:27], s49 offen offset:0 nt lds
    buffer_load_dwordx4 v4, s[24:27], s49 offen offset:1024 nt lds
    buffer_load_dwordx4 v4, s[24:27], s49 offen offset:2048 nt lds
    buffer_load_dwordx4 v4, s[24:27], s49 offen offset:3072 nt lds
    s_add_u32 m0, s46, 4096
    s_add_u32 s49, s45, 4096
    buffer_load_dwordx4 v4, s[24:27], s49 offen offset:0 nt lds
    buffer_load_dwordx4 v4, s[24:27], s49 offen offset:1024 nt lds
    buffer_load_dwordx4 v4, s[24:27], s49 offen offset:2048 nt lds
    buffer_load_dwordx4 v4, s[24:27], s49 offen offset:3072 nt lds
    s_add_u32 s45, s45, 8192
    s_add_u32 s47, s47, 8192
    s_and_b32 s47, s47, 0xffff
    s_waitcnt vmcnt(44)
    s_barrier
    s_add_u32 s46, s47, 98304
    s_add_u32 m0, s46, 0
    s_add_u32 s49, s45, 0
    buffer_load_dwordx4 v4, s[24:27], s49 offen offset:0 nt lds
    buffer_load_dwordx4 v4, s[24:27], s49 offen offset:1024 nt lds
    buffer_load_dwordx4 v4, s[24:27], s49 offen offset:2048 nt lds
    buffer_load_dwordx4 v4, s[24:27], s49 offen offset:3072 nt lds
    s_add_u32 m0, s46, 4096
    s_add_u32 s49, s45, 4096
    buffer_load_dwordx4 v4, s[24:27], s49 offen offset:0 nt lds
    buffer_load_dwordx4 v4, s[24:27], s49 offen offset:1024 nt lds
    buffer_load_dwordx4 v4, s[24:27], s49 offen offset:2048 nt lds
    buffer_load_dwordx4 v4, s[24:27], s49 offen offset:3072 nt lds
    s_add_u32 s45, s45, 8192
    s_add_u32 s47, s47, 8192
    s_and_b32 s47, s47, 0xffff
    s_waitcnt vmcnt(42)
    s_barrier
    s_add_u32 s46, s47, 98304
    s_add_u32 m0, s46, 0
    s_add_u32 s49, s45, 0
    buffer_load_dwordx4 v4, s[24:27], s49 offen offset:0 nt lds
    buffer_load_dwordx4 v4, s[24:27], s49 offen offset:1024 nt lds
    buffer_load_dwordx4 v4, s[24:27], s49 offen offset:2048 nt lds
    buffer_load_dwordx4 v4, s[24:27], s49 offen offset:3072 nt lds
    s_add_u32 m0, s46, 4096
    s_add_u32 s49, s45, 4096
    buffer_load_dwordx4 v4, s[24:27], s49 offen offset:0 nt lds
    buffer_load_dwordx4 v4, s[24:27], s49 offen offset:1024 nt lds
    buffer_load_dwordx4 v4, s[24:27], s49 offen offset:2048 nt lds
    buffer_load_dwordx4 v4, s[24:27], s49 offen offset:3072 nt lds
    s_add_u32 s45, s45, 8192
    s_add_u32 s47, s47, 8192
    s_and_b32 s47, s47, 0xffff
    s_mov_b32 s44, 0
L_V_lp1:
    s_waitcnt vmcnt(40)
    s_barrier
    s_add_u32 s46, s47, 98304
    s_add_u32 m0, s46, 0
    s_add_u32 s49, s45, 0
    buffer_load_dwordx4 v4, s[24:27], s49 offen offset:0 nt lds
    buffer_load_dwordx4 v4, s[24:27], s49 offen offset:1024 nt lds
    buffer_load_dwordx4 v4, s[24:27], s49 offen offset:2048 nt lds
    buffer_load_dwordx4 v4, s[24:27], s49 offen offset:3072 nt lds
    s_add_u32 m0, s46, 4096
    s_add_u32 s49, s45, 4096
    buffer_load_dwordx4 v4, s[24:27], s49 offen offset:0 nt lds
    buffer_load_dwordx4 v4, s[24:27], s49 offen offset:1024 nt lds
    buffer_load_dwordx4 v4, s[24:27], s49 offen offset:2048 nt lds
    buffer_load_dwordx4 v4, s[24:27], s49 offen offset:3072 nt lds
    s_add_u32 s45, s45, 8192
    s_add_u32 s47, s47, 8192
    s_and_b32 s47, s47, 0xffff
    s_add_u32 s44, s44, 1
    s_cmp_lt_u32 s44, 5
    s_cbranch_scc1 L_V_lp1
    s_waitcnt vmcnt(40)
    s_barrier
    s_lshl_b32 s54, s59, 7
    s_add_u32 s54, s54, 2433024
    s_mov_b32 m0, 73728
    s_add_u32 s55, s54, 8192
    buffer_load_dwordx4 v12, s[36:39], s54 offen lds
    buffer_load_dwordx4 v12, s[36:39], s55 offen offset:1024 lds
    s_add_u32 s54, s54, 18432
    s_mov_b32 m0, 75776
    s_add_u32 s55, s54, 8192
    buffer_load_dwordx4 v12, s[36:39], s54 offen lds
    buffer_load_dwordx4 v12, s[36:39], s55 offen offset:1024 lds
    s_add_u32 s54, s54, 18432
    s_mov_b32 m0, 77824
    s_add_u32 s55, s54, 8192
    buffer_load_dwordx4 v12, s[36:39], s54 offen lds
    buffer_load_dwordx4 v12, s[36:39], s55 offen offset:1024 lds
    s_add_u32 s54, s54, 18432
    s_mov_b32 m0, 79872
    s_add_u32 s55, s54, 8192
    buffer_load_dwordx4 v12, s[36:39], s54 offen lds
    buffer_load_dwordx4 v12, s[36:39], s55 offen offset:1024 lds
    s_waitcnt vmcnt(40)
    s_barrier
    s_lshl_b32 s54, s59, 7
    s_add_u32 s54, s54, 3538944
    s_mov_b32 m0, 98304
    s_add_u32 s55, s54, 8192
    buffer_load_dwordx4 v12, s[36:39], s54 offen lds
    buffer_load_dwordx4 v12, s[36:39], s55 offen offset:1024 lds
    s_add_u32 s54, s54, 18432
    s_mov_b32 m0, 100352
    s_add_u32 s55, s54, 8192
    buffer_load_dwordx4 v12, s[36:39], s54 offen lds
    buffer_load_dwordx4 v12, s[36:39], s55 offen offset:1024 lds
    s_add_u32 s54, s54, 18432
    s_mov_b32 m0, 102400
    s_add_u32 s55, s54, 8192
    buffer_load_dwordx4 v12, s[36:39], s54 offen lds
    buffer_load_dwordx4 v12, s[36:39], s55 offen offset:1024 lds
    s_add_u32 s54, s54, 18432
    s_mov_b32 m0, 104448
    s_add_u32 s55, s54, 8192
    buffer_load_dwordx4 v12, s[36:39], s54 offen lds
    buffer_load_dwordx4 v12, s[36:39], s55 offen offset:1024 lds
    s_lshl_b32 s54, s59, 7
    s_add_u32 s54, s54, 3612672
    s_mov_b32 m0, 106496
    s_add_u32 s55, s54, 8192
    buffer_load_dwordx4 v12, s[36:39], s54 offen lds
    buffer_load_dwordx4 v12, s[36:39], s55 offen offset:1024 lds
    s_add_u32 s54, s54, 18432
    s_mov_b32 m0, 108544
    s_add_u32 s55, s54, 8192
    buffer_load_dwordx4 v12, s[36:39], s54 offen lds
    buffer_load_dwordx4 v12, s[36:39], s55 offen offset:1024 lds
    s_add_u32 s54, s54, 18432
    s_mov_b32 m0, 110592
    s_add_u32 s55, s54, 8192
    buffer_load_dwordx4 v12, s[36:39], s54 offen lds
    buffer_load_dwordx4 v12, s[36:39], s55 offen offset:1024 lds
    s_add_u32 s54, s54, 18432
    s_mov_b32 m0, 112640
    s_add_u32 s55, s54, 8192
    buffer_load_dwordx4 v12, s[36:39], s54 offen lds
    buffer_load_dwordx4 v12, s[36:39], s55 offen offset:1024 lds
    s_waitcnt vmcnt(48)
    s_barrier
    s_lshl_b32 s54, s59, 7
    s_add_u32 s54, s54, 3686400
    s_mov_b32 m0, 114688
    s_add_u32 s55, s54, 8192
    buffer_load_dwordx4 v12, s[36:39], s54 offen lds
    buffer_load_dwordx4 v12, s[36:39], s55 offen offset:1024 lds
    s_add_u32 s54, s54, 18432
    s_mov_b32 m0, 116736
    s_add_u32 s55, s54, 8192
    buffer_load_dwordx4 v12, s[36:39], s54 offen lds
    buffer_load_dwordx4 v12, s[36:39], s55 offen offset:1024 lds
    s_add_u32 s54, s54, 18432
    s_mov_b32 m0, 118784
    s_add_u32 s55, s54, 8192
    buffer_load_dwordx4 v12, s[36:39], s54 offen lds
    buffer_load_dwordx4 v12, s[36:39], s55 offen offset:1024 lds
    s_add_u32 s54, s54, 18432
    s_mov_b32 m0, 120832
    s_add_u32 s55, s54, 8192
    buffer_load_dwordx4 v12, s[36:39], s54 offen lds
    buffer_load_dwordx4 v12, s[36:39], s55 offen offset:1024 lds
    s_lshl_b32 s54, s59, 7
    s_add_u32 s54, s54, 2506752
    s_mov_b32 m0, 81920
    s_add_u32 s55, s54, 8192
    buffer_load_dwordx4 v12, s[36:39], s54 offen lds
    buffer_load_dwordx4 v12, s[36:39], s55 offen offset:1024 lds
    s_add_u32 s54, s54, 18432
    s_mov_b32 m0, 83968
    s_add_u32 s55, s54, 8192
    buffer_load_dwordx4 v12, s[36:39], s54 offen lds
    buffer_load_dwordx4 v12, s[36:39], s55 offen offset:1024 lds
    s_add_u32 s54, s54, 18432
    s_mov_b32 m0, 86016
    s_add_u32 s55, s54, 8192
    buffer_load_dwordx4 v12, s[36:39], s54 offen lds
    buffer_load_dwordx4 v12, s[36:39], s55 offen offset:1024 lds
    s_add_u32 s54, s54, 18432
    s_mov_b32 m0, 88064
    s_add_u32 s55, s54, 8192
    buffer_load_dwordx4 v12, s[36:39], s54 offen lds
    buffer_load_dwordx4 v12, s[36:39], s55 offen offset:1024 lds
    s_waitcnt vmcnt(56)
    s_barrier
    s_lshl_b32 s54, s59, 7
    s_add_u32 s54, s54, 3760128
    s_mov_b32 m0, 122880
    s_add_u32 s55, s54, 8192
    buffer_load_dwordx4 v12, s[36:39], s54 offen lds
    buffer_load_dwordx4 v12, s[36:39], s55 offen offset:1024 lds
    s_add_u32 s54, s54, 18432
    s_mov_b32 m0, 124928
    s_add_u32 s55, s54, 8192
    buffer_load_dwordx4 v12, s[36:39], s54 offen lds
    buffer_load_dwordx4 v12, s[36:39], s55 offen offset:1024 lds
    s_add_u32 s54, s54, 18432
    s_mov_b32 m0, 126976
    s_add_u32 s55, s54, 8192
    buffer_load_dwordx4 v12, s[36:39], s54 offen lds
    buffer_load_dwordx4 v12, s[36:39], s55 offen offset:1024 lds
    s_add_u32 s54, s54, 18432
    s_mov_b32 m0, 129024
    s_add_u32 s55, s54, 8192
    buffer_load_dwordx4 v12, s[36:39], s54 offen lds
    buffer_load_dwordx4 v12, s[36:39], s55 offen offset:1024 lds
    s_waitcnt vmcnt(56)
    s_barrier
    s_waitcnt vmcnt(48)
    s_barrier
    s_waitcnt vmcnt(0)
    s_barrier
    s_barrier
    v_mov_b32 v5, v12
    s_mov_b32 s63, 3
    s_mov_b32 s61, 147456
    s_branch L_helper1
L_cons:
    s_getpc_b64 s[34:35]
L_pc:
    s_mul_i32 s24, s23, 6144
    v_lshlrev_b32 v3, 4, v0
    v_add_u32 v3, s24, v3
    s_mov_b32 s25, L_end-L_pc-12
    v_min_u32 v48, s25, v3
    v_add_u32 v3, 1024, v3
    v_min_u32 v49, s25, v3
    v_add_u32 v3, 1024, v3
    v_min_u32 v50, s25, v3
    v_add_u32 v3, 1024, v3
    v_min_u32 v51, s25, v3
    v_add_u32 v3, 1024, v3
    v_min_u32 v52, s25, v3
    v_add_u32 v3, 1024, v3
    v_min_u32 v53, s25, v3
    v_add_u32 v3, 1024, v3
    global_load_dwordx4 v[128:131], v48, s[34:35]
    global_load_dwordx4 v[132:135], v49, s[34:35]
    global_load_dwordx4 v[136:139], v50, s[34:35]
    global_load_dwordx4 v[140:143], v51, s[34:35]
    global_load_dwordx4 v[144:147], v52, s[34:35]
    global_load_dwordx4 v[148:151], v53, s[34:35]
    v_lshrrev_b32 v1, 5, v0
    v_and_b32 v2, 31, v0
    v_and_b32 v3, 15, v0
    v_xor_b32 v48, v1, v3
    v_lshlrev_b32 v48, 4, v48
    v_lshlrev_b32 v49, 8, v2
    v_add_u32 v4, v48, v49
    v_xor_b32 v5, 32, v4
    v_xor_b32 v6, 64, v4
    v_xor_b32 v7, 96, v4
    v_xor_b32 v8, 128, v4
    v_xor_b32 v9, 160, v4
    v_xor_b32 v10, 192, v4
    v_xor_b32 v11, 224, v4
    v_lshrrev_b32 v50, 2, v3
    v_bfe_u32 v51, v0, 4, 1
    v_and_b32 v52, 3, v0
    v_lshlrev_b32 v53, 2, v1
    v_add_u32 v53, v53, v50
    v_lshlrev_b32 v53, 8, v53
    v_lshlrev_b32 v54, 5, v51
    v_add_u32 v53, v53, v54
    v_lshlrev_b32 v54, 3, v52
    v_add_u32 v53, v53, v54
    v_add_u32 v53, 98304, v53
    v_xor_b32 v54, 0, v50
    v_lshlrev_b32 v54, 6, v54
    v_add_u32 v12, v53, v54
    v_xor_b32 v54, 1, v50
    v_lshlrev_b32 v54, 6, v54
    v_add_u32 v13, v53, v54
    v_xor_b32 v54, 2, v50
    v_lshlrev_b32 v54, 6, v54
    v_add_u32 v14, v53, v54
    v_xor_b32 v54, 3, v50
    v_lshlrev_b32 v54, 6, v54
    v_add_u32 v15, v53, v54
    v_lshlrev_b32 v53, 3, v1
    v_add_u32 v53, v53, v50
    v_lshlrev_b32 v53, 8, v53
    v_lshlrev_b32 v54, 5, v51
    v_add_u32 v53, v53, v54
    v_and_b32 v54, 1, v52
    v_lshlrev_b32 v54, 4, v54
    v_add_u32 v53, v53, v54
    v_lshrrev_b32 v54, 1, v52
    v_lshlrev_b32 v54, 3, v54
    v_add_u32 v53, v53, v54
    v_xor_b32 v54, 0, v50
    v_lshlrev_b32 v54, 6, v54
    v_add_u32 v96, v53, v54
    v_xor_b32 v54, 1, v50
    v_lshlrev_b32 v54, 6, v54
    v_add_u32 v97, v53, v54
    v_xor_b32 v54, 2, v50
    v_lshlrev_b32 v54, 6, v54
    v_add_u32 v98, v53, v54
    v_xor_b32 v54, 3, v50
    v_lshlrev_b32 v54, 6, v54
    v_add_u32 v99, v53, v54
    s_lshl_b32 s24, s23, 11
    v_lshlrev_b32 v53, 6, v2
    v_add_u32 v53, s24, v53
    v_bfe_u32 v54, v2, 2, 2
    v_xor_b32 v54, v54, v1
    v_lshlrev_b32 v54, 4, v54
    v_add_u32 v100, v53, v54
    v_xor_b32 v101, 32, v100
    v_mov_b32 v16, 0
    v_mov_b32 v17, 0
    v_mov_b32 v18, 0
    v_mov_b32 v19, 0
    v_mov_b32 v20, 0
    v_mov_b32 v21, 0
    v_mov_b32 v22, 0
    v_mov_b32 v23, 0
    v_mov_b32 v24, 0
    v_mov_b32 v25, 0
    v_mov_b32 v26, 0
    v_mov_b32 v27, 0
    v_mov_b32 v28, 0
    v_mov_b32 v29, 0
    v_mov_b32 v30, 0
    v_mov_b32 v31, 0
    v_mov_b32 v32, 0
    v_mov_b32 v33, 0
    v_mov_b32 v34, 0
    v_mov_b32 v35, 0
    v_mov_b32 v36, 0
    v_mov_b32 v37, 0
    v_mov_b32 v38, 0
    v_mov_b32 v39, 0
    v_mov_b32 v40, 0
    v_mov_b32 v41, 0
    v_mov_b32 v42, 0
    v_mov_b32 v43, 0
    v_mov_b32 v44, 0
    v_mov_b32 v45, 0
    v_mov_b32 v46, 0
    v_mov_b32 v47, 0
    v_mov_b32 v48, 0
    v_mov_b32 v49, 0
    v_mov_b32 v50, 0
    v_mov_b32 v51, 0
    v_mov_b32 v52, 0
    v_mov_b32 v53, 0
    v_mov_b32 v54, 0
    v_mov_b32 v55, 0
    v_mov_b32 v56, 0
    v_mov_b32 v57, 0
    v_mov_b32 v58, 0
    v_mov_b32 v59, 0
    v_mov_b32 v60, 0
    v_mov_b32 v61, 0
    v_mov_b32 v62, 0
    v_mov_b32 v63, 0
    v_mov_b32 v64, 0
    v_mov_b32 v65, 0
    v_mov_b32 v66, 0
    v_mov_b32 v67, 0
    v_mov_b32 v68, 0
    v_mov_b32 v69, 0
    v_mov_b32 v70, 0
    v_mov_b32 v71, 0
    v_mov_b32 v72, 0
    v_mov_b32 v73, 0
    v_mov_b32 v74, 0
    v_mov_b32 v75, 0
    v_mov_b32 v76, 0
    v_mov_b32 v77, 0
    v_mov_b32 v78, 0
    v_mov_b32 v79, 0
    s_memrealtime s[60:61]
    s_waitcnt vmcnt(0) lgkmcnt(0)
    s_mov_b32 s52, s16
    s_mov_b32 s53, s17
    s_mov_b32 s54, 256
    s_mov_b32 s55, 0x20000
    s_or_b32 s24, s2, s23
    s_cmp_lg_u32 s24, 0
    s_cbranch_scc1 L_noepoch
    s_or_b32 s60, s60, 1
    v_mov_b32 v188, s60
    v_mov_b32 v189, s61
    v_mov_b32 v190, 0
    s_mov_b64 exec, 1
    buffer_store_dwordx2 v[188:189], v190, s[52:55], 0 offen offset:128 sc1
    s_mov_b64 exec, -1
L_noepoch:
    v_mov_b32 v128, 0
    v_mov_b32 v129, 0
    v_mov_b32 v130, 0
    v_mov_b32 v131, 0
    v_mov_b32 v132, 0
    v_mov_b32 v133, 0
    v_mov_b32 v134, 0
    v_mov_b32 v135, 0
    v_mov_b32 v136, 0
    v_mov_b32 v137, 0
    v_mov_b32 v138, 0
    v_mov_b32 v139, 0
    v_mov_b32 v140, 0
    v_mov_b32 v141, 0
    v_mov_b32 v142, 0
    v_mov_b32 v143, 0
    v_mov_b32 v144, 0
    v_mov_b32 v145, 0
    v_mov_b32 v146, 0
    v_mov_b32 v147, 0
    v_mov_b32 v148, 0
    v_mov_b32 v149, 0
    v_mov_b32 v150, 0
    v_mov_b32 v151, 0
    v_mov_b32 v152, 0
    v_mov_b32 v153, 0
    v_mov_b32 v154, 0
    v_mov_b32 v155, 0
    v_mov_b32 v156, 0
    v_mov_b32 v157, 0
    v_mov_b32 v158, 0
    v_mov_b32 v159, 0
    v_mov_b32 v160, 0
    v_mov_b32 v161, 0
    v_mov_b32 v162, 0
    v_mov_b32 v163, 0
    v_mov_b32 v164, 0
    v_mov_b32 v165, 0
    v_mov_b32 v166, 0
    v_mov_b32 v167, 0
    v_mov_b32 v168, 0
    v_mov_b32 v169, 0
    v_mov_b32 v170, 0
    v_mov_b32 v171, 0
    v_mov_b32 v172, 0
    v_mov_b32 v173, 0
    v_mov_b32 v174, 0
    v_mov_b32 v175, 0
    v_mov_b32 v176, 0
    v_mov_b32 v177, 0
    v_mov_b32 v178, 0
    v_mov_b32 v179, 0
    v_mov_b32 v180, 0
    v_mov_b32 v181, 0
    v_mov_b32 v182, 0
    v_mov_b32 v183, 0
    v_mov_b32 v184, 0
    v_mov_b32 v185, 0
    v_mov_b32 v186, 0
    v_mov_b32 v187, 0
    v_mov_b32 v188, 0
    v_mov_b32 v189, 0
    v_mov_b32 v190, 0
    v_mov_b32 v191, 0
    v_add_u32 v102, 0x10000, v96
    v_add_u32 v103, 0x10000, v97
    v_add_u32 v104, 0x10000, v98
    v_add_u32 v105, 0x10000, v99
    v_add_u32 v100, 81920, v100
    v_add_u32 v101, 81920, v101
    v_add_u32 v106, 0x10000, v100
    v_add_u32 v107, 0x10000, v101
    s_mul_i32 s24, s20, 7
    s_lshl_b32 s25, s23, 1
    s_add_u32 s24, s24, s25
    s_lshl_b32 s24, s24, 8
    s_lshl_b32 s25, s21, 3
    s_add_u32 s24, s24, s25
    s_lshl_b32 s39, s24, 9
    v_bfe_u32 v2, v0, 4, 1
    v_lshlrev_b32 v2, 17, v2
    v_lshrrev_b32 v1, 5, v0
    v_lshlrev_b32 v1, 8, v1
    v_add_u32 v2, v2, v1
    v_and_b32 v1, 15, v0
    v_lshlrev_b32 v1, 4, v1
    v_add_u32 v2, v2, v1
    s_mov_b32 s40, s18
    s_mov_b32 s41, s19
    s_mov_b32 s42, 7340032
    s_mov_b32 s43, 0x20000
    s_mov_b64 s[36:37], -1
    s_cmp_eq_u32 s23, 3
    s_cselect_b32 s36, 0xffff, s36
    s_cselect_b32 s37, 0xffff, s37
    s_mov_b32 s32, 0x30800000
    s_mov_b32 s33, 0x4e800000
    s_barrier
    ds_read_b128 v[80:83], v100 offset:24576
    ds_read_b128 v[84:87], v101 offset:24576
    ds_read_b64_tr_b16 a[0:1], v96 offset:8192
    ds_read_b64_tr_b16 a[2:3], v96 offset:9216
    ds_read_b64_tr_b16 a[4:5], v97 offset:8192
    ds_read_b64_tr_b16 a[6:7], v97 offset:9216
    ds_read_b64_tr_b16 a[8:9], v98 offset:8192
    ds_read_b64_tr_b16 a[10:11], v98 offset:9216
    ds_read_b64_tr_b16 a[12:13], v99 offset:8192
    ds_read_b64_tr_b16 a[14:15], v99 offset:9216
    ds_read_b64_tr_b16 a[16:17], v96 offset:12288
    ds_read_b64_tr_b16 a[18:19], v96 offset:13312
    ds_read_b64_tr_b16 a[20:21], v97 offset:12288
    ds_read_b64_tr_b16 a[22:23], v97 offset:13312
    ds_read_b64_tr_b16 a[24:25], v98 offset:12288
    ds_read_b64_tr_b16 a[26:27], v98 offset:13312
    ds_read_b64_tr_b16 a[28:29], v99 offset:12288
    ds_read_b64_tr_b16 a[30:31], v99 offset:13312
    s_waitcnt lgkmcnt(0)
    v_mfma_f32_32x32x16_bf16 v[16:31], a[0:3], v[80:83], v[16:31]
    ds_read_b128 v[88:91], v100 offset:32768
    ds_read_b128 v[92:95], v101 offset:32768
    ds_read_b64_tr_b16 a[32:33], v96 offset:16384
    v_mfma_f32_32x32x16_bf16 v[32:47], a[4:7], v[80:83], v[32:47]
    ds_read_b64_tr_b16 a[34:35], v96 offset:17408
    ds_read_b64_tr_b16 a[36:37], v97 offset:16384
    ds_read_b64_tr_b16 a[38:39], v97 offset:17408
    v_mfma_f32_32x32x16_bf16 v[48:63], a[8:11], v[80:83], v[48:63]
    ds_read_b64_tr_b16 a[40:41], v98 offset:16384
    ds_read_b64_tr_b16 a[42:43], v98 offset:17408
    ds_read_b64_tr_b16 a[44:45], v99 offset:16384
    v_mfma_f32_32x32x16_bf16 v[64:79], a[12:15], v[80:83], v[64:79]
    ds_read_b64_tr_b16 a[46:47], v99 offset:17408
    ds_read_b64_tr_b16 a[48:49], v96 offset:20480
    ds_read_b64_tr_b16 a[50:51], v96 offset:21504
    v_mfma_f32_32x32x16_bf16 v[16:31], a[16:19], v[84:87], v[16:31]
    ds_read_b64_tr_b16 a[52:53], v97 offset:20480
    ds_read_b64_tr_b16 a[54:55], v97 offset:21504
    ds_read_b64_tr_b16 a[56:57], v98 offset:20480
    v_mfma_f32_32x32x16_bf16 v[32:47], a[20:23], v[84:87], v[32:47]
    ds_read_b64_tr_b16 a[58:59], v98 offset:21504
    ds_read_b64_tr_b16 a[60:61], v99 offset:20480
    ds_read_b64_tr_b16 a[62:63], v99 offset:21504
    v_mfma_f32_32x32x16_bf16 v[48:63], a[24:27], v[84:87], v[48:63]
    v_mfma_f32_32x32x16_bf16 v[64:79], a[28:31], v[84:87], v[64:79]
    s_waitcnt lgkmcnt(0)
    v_mfma_f32_32x32x16_bf16 v[16:31], a[32:35], v[88:91], v[16:31]
    ds_read_b128 v[80:83], v100 offset:40960
    ds_read_b128 v[84:87], v101 offset:40960
    ds_read_b64_tr_b16 a[0:1], v96 offset:24576
    v_mfma_f32_32x32x16_bf16 v[32:47], a[36:39], v[88:91], v[32:47]
    ds_read_b64_tr_b16 a[2:3], v96 offset:25600
    ds_read_b64_tr_b16 a[4:5], v97 offset:24576
    ds_read_b64_tr_b16 a[6:7], v97 offset:25600
    v_mfma_f32_32x32x16_bf16 v[48:63], a[40:43], v[88:91], v[48:63]
    ds_read_b64_tr_b16 a[8:9], v98 offset:24576
    ds_read_b64_tr_b16 a[10:11], v98 offset:25600
    ds_read_b64_tr_b16 a[12:13], v99 offset:24576
    v_mfma_f32_32x32x16_bf16 v[64:79], a[44:47], v[88:91], v[64:79]
    ds_read_b64_tr_b16 a[14:15], v99 offset:25600
    ds_read_b64_tr_b16 a[16:17], v96 offset:28672
    ds_read_b64_tr_b16 a[18:19], v96 offset:29696
    v_mfma_f32_32x32x16_bf16 v[16:31], a[48:51], v[92:95], v[16:31]
    ds_read_b64_tr_b16 a[20:21], v97 offset:28672
    ds_read_b64_tr_b16 a[22:23], v97 offset:29696
    ds_read_b64_tr_b16 a[24:25], v98 offset:28672
    v_mfma_f32_32x32x16_bf16 v[32:47], a[52:55], v[92:95], v[32:47]
    ds_read_b64_tr_b16 a[26:27], v98 offset:29696
    ds_read_b64_tr_b16 a[28:29], v99 offset:28672
    ds_read_b64_tr_b16 a[30:31], v99 offset:29696
    v_mfma_f32_32x32x16_bf16 v[48:63], a[56:59], v[92:95], v[48:63]
    v_mfma_f32_32x32x16_bf16 v[64:79], a[60:63], v[92:95], v[64:79]
    s_barrier
    s_waitcnt lgkmcnt(0)
    v_mfma_f32_32x32x16_bf16 v[16:31], a[0:3], v[80:83], v[16:31]
    ds_read_b128 v[88:91], v100 offset:49152
    ds_read_b128 v[92:95], v101 offset:49152
    ds_read_b64_tr_b16 a[32:33], v96 offset:32768
    v_mfma_f32_32x32x16_bf16 v[32:47], a[4:7], v[80:83], v[32:47]
    ds_read_b64_tr_b16 a[34:35], v96 offset:33792
    ds_read_b64_tr_b16 a[36:37], v97 offset:32768
    ds_read_b64_tr_b16 a[38:39], v97 offset:33792
    v_mfma_f32_32x32x16_bf16 v[48:63], a[8:11], v[80:83], v[48:63]
    ds_read_b64_tr_b16 a[40:41], v98 offset:32768
    ds_read_b64_tr_b16 a[42:43], v98 offset:33792
    ds_read_b64_tr_b16 a[44:45], v99 offset:32768
    v_mfma_f32_32x32x16_bf16 v[64:79], a[12:15], v[80:83], v[64:79]
    ds_read_b64_tr_b16 a[46:47], v99 offset:33792
    ds_read_b64_tr_b16 a[48:49], v96 offset:36864
    ds_read_b64_tr_b16 a[50:51], v96 offset:37888
    v_mfma_f32_32x32x16_bf16 v[16:31], a[16:19], v[84:87], v[16:31]
    ds_read_b64_tr_b16 a[52:53], v97 offset:36864
    ds_read_b64_tr_b16 a[54:55], v97 offset:37888
    ds_read_b64_tr_b16 a[56:57], v98 offset:36864
    v_mfma_f32_32x32x16_bf16 v[32:47], a[20:23], v[84:87], v[32:47]
    ds_read_b64_tr_b16 a[58:59], v98 offset:37888
    ds_read_b64_tr_b16 a[60:61], v99 offset:36864
    ds_read_b64_tr_b16 a[62:63], v99 offset:37888
    v_mfma_f32_32x32x16_bf16 v[48:63], a[24:27], v[84:87], v[48:63]
    v_mfma_f32_32x32x16_bf16 v[64:79], a[28:31], v[84:87], v[64:79]
    s_waitcnt lgkmcnt(0)
    v_mfma_f32_32x32x16_bf16 v[16:31], a[32:35], v[88:91], v[16:31]
    ds_read_b128 v[80:83], v100 offset:57344
    ds_read_b128 v[84:87], v101 offset:57344
    ds_read_b64_tr_b16 a[0:1], v96 offset:40960
    v_mfma_f32_32x32x16_bf16 v[32:47], a[36:39], v[88:91], v[32:47]
    ds_read_b64_tr_b16 a[2:3], v96 offset:41984
    ds_read_b64_tr_b16 a[4:5], v97 offset:40960
    ds_read_b64_tr_b16 a[6:7], v97 offset:41984
    v_mfma_f32_32x32x16_bf16 v[48:63], a[40:43], v[88:91], v[48:63]
    ds_read_b64_tr_b16 a[8:9], v98 offset:40960
    ds_read_b64_tr_b16 a[10:11], v98 offset:41984
    ds_read_b64_tr_b16 a[12:13], v99 offset:40960
    v_mfma_f32_32x32x16_bf16 v[64:79], a[44:47], v[88:91], v[64:79]
    ds_read_b64_tr_b16 a[14:15], v99 offset:41984
    ds_read_b64_tr_b16 a[16:17], v96 offset:45056
    ds_read_b64_tr_b16 a[18:19], v96 offset:46080
    v_mfma_f32_32x32x16_bf16 v[16:31], a[48:51], v[92:95], v[16:31]
    ds_read_b64_tr_b16 a[20:21], v97 offset:45056
    ds_read_b64_tr_b16 a[22:23], v97 offset:46080
    ds_read_b64_tr_b16 a[24:25], v98 offset:45056
    v_mfma_f32_32x32x16_bf16 v[32:47], a[52:55], v[92:95], v[32:47]
    ds_read_b64_tr_b16 a[26:27], v98 offset:46080
    ds_read_b64_tr_b16 a[28:29], v99 offset:45056
    ds_read_b64_tr_b16 a[30:31], v99 offset:46080
    v_mfma_f32_32x32x16_bf16 v[48:63], a[56:59], v[92:95], v[48:63]
    v_mfma_f32_32x32x16_bf16 v[64:79], a[60:63], v[92:95], v[64:79]
    s_barrier
    s_waitcnt lgkmcnt(0)
    v_mfma_f32_32x32x16_bf16 v[16:31], a[0:3], v[80:83], v[16:31]
    ds_read_b128 v[88:91], v106 offset:0
    ds_read_b128 v[92:95], v107 offset:0
    ds_read_b64_tr_b16 a[32:33], v96 offset:49152
    v_mfma_f32_32x32x16_bf16 v[32:47], a[4:7], v[80:83], v[32:47]
    ds_read_b64_tr_b16 a[34:35], v96 offset:50176
    ds_read_b64_tr_b16 a[36:37], v97 offset:49152
    ds_read_b64_tr_b16 a[38:39], v97 offset:50176
    v_mfma_f32_32x32x16_bf16 v[48:63], a[8:11], v[80:83], v[48:63]
    ds_read_b64_tr_b16 a[40:41], v98 offset:49152
    ds_read_b64_tr_b16 a[42:43], v98 offset:50176
    ds_read_b64_tr_b16 a[44:45], v99 offset:49152
    v_mfma_f32_32x32x16_bf16 v[64:79], a[12:15], v[80:83], v[64:79]
    ds_read_b64_tr_b16 a[46:47], v99 offset:50176
    ds_read_b64_tr_b16 a[48:49], v96 offset:53248
    ds_read_b64_tr_b16 a[50:51], v96 offset:54272
    v_mfma_f32_32x32x16_bf16 v[16:31], a[16:19], v[84:87], v[16:31]
    ds_read_b64_tr_b16 a[52:53], v97 offset:53248
    ds_read_b64_tr_b16 a[54:55], v97 offset:54272
    ds_read_b64_tr_b16 a[56:57], v98 offset:53248
    v_mfma_f32_32x32x16_bf16 v[32:47], a[20:23], v[84:87], v[32:47]
    ds_read_b64_tr_b16 a[58:59], v98 offset:54272
    ds_read_b64_tr_b16 a[60:61], v99 offset:53248
    ds_read_b64_tr_b16 a[62:63], v99 offset:54272
    v_mfma_f32_32x32x16_bf16 v[48:63], a[24:27], v[84:87], v[48:63]
    v_mfma_f32_32x32x16_bf16 v[64:79], a[28:31], v[84:87], v[64:79]
    s_waitcnt lgkmcnt(0)
    v_mfma_f32_32x32x16_bf16 v[16:31], a[32:35], v[88:91], v[16:31]
    ds_read_b128 v[80:83], v106 offset:8192
    ds_read_b128 v[84:87], v107 offset:8192
    ds_read_b64_tr_b16 a[0:1], v96 offset:57344
    v_mfma_f32_32x32x16_bf16 v[32:47], a[36:39], v[88:91], v[32:47]
    ds_read_b64_tr_b16 a[2:3], v96 offset:58368
    ds_read_b64_tr_b16 a[4:5], v97 offset:57344
    ds_read_b64_tr_b16 a[6:7], v97 offset:58368
    v_mfma_f32_32x32x16_bf16 v[48:63], a[40:43], v[88:91], v[48:63]
    ds_read_b64_tr_b16 a[8:9], v98 offset:57344
    ds_read_b64_tr_b16 a[10:11], v98 offset:58368
    ds_read_b64_tr_b16 a[12:13], v99 offset:57344
    v_mfma_f32_32x32x16_bf16 v[64:79], a[44:47], v[88:91], v[64:79]
    ds_read_b64_tr_b16 a[14:15], v99 offset:58368
    ds_read_b64_tr_b16 a[16:17], v96 offset:61440
    ds_read_b64_tr_b16 a[18:19], v96 offset:62464
    v_mfma_f32_32x32x16_bf16 v[16:31], a[48:51], v[92:95], v[16:31]
    ds_read_b64_tr_b16 a[20:21], v97 offset:61440
    ds_read_b64_tr_b16 a[22:23], v97 offset:62464
    ds_read_b64_tr_b16 a[24:25], v98 offset:61440
    v_mfma_f32_32x32x16_bf16 v[32:47], a[52:55], v[92:95], v[32:47]
    ds_read_b64_tr_b16 a[26:27], v98 offset:62464
    ds_read_b64_tr_b16 a[28:29], v99 offset:61440
    ds_read_b64_tr_b16 a[30:31], v99 offset:62464
    v_mfma_f32_32x32x16_bf16 v[48:63], a[56:59], v[92:95], v[48:63]
    v_mfma_f32_32x32x16_bf16 v[64:79], a[60:63], v[92:95], v[64:79]
    s_barrier
    s_waitcnt lgkmcnt(0)
    v_mfma_f32_32x32x16_bf16 v[16:31], a[0:3], v[80:83], v[16:31]
    ds_read_b128 v[88:91], v100 offset:0
    ds_read_b128 v[92:95], v101 offset:0
    ds_read_b64_tr_b16 a[32:33], v102 offset:0
    v_mfma_f32_32x32x16_bf16 v[32:47], a[4:7], v[80:83], v[32:47]
    ds_read_b64_tr_b16 a[34:35], v102 offset:1024
    ds_read_b64_tr_b16 a[36:37], v103 offset:0
    ds_read_b64_tr_b16 a[38:39], v103 offset:1024
    v_mfma_f32_32x32x16_bf16 v[48:63], a[8:11], v[80:83], v[48:63]
    ds_read_b64_tr_b16 a[40:41], v104 offset:0
    ds_read_b64_tr_b16 a[42:43], v104 offset:1024
    ds_read_b64_tr_b16 a[44:45], v105 offset:0
    v_mfma_f32_32x32x16_bf16 v[64:79], a[12:15], v[80:83], v[64:79]
    ds_read_b64_tr_b16 a[46:47], v105 offset:1024
    ds_read_b64_tr_b16 a[48:49], v102 offset:4096
    ds_read_b64_tr_b16 a[50:51], v102 offset:5120
    v_mfma_f32_32x32x16_bf16 v[16:31], a[16:19], v[84:87], v[16:31]
    ds_read_b64_tr_b16 a[52:53], v103 offset:4096
    ds_read_b64_tr_b16 a[54:55], v103 offset:5120
    ds_read_b64_tr_b16 a[56:57], v104 offset:4096
    v_mfma_f32_32x32x16_bf16 v[32:47], a[20:23], v[84:87], v[32:47]
    ds_read_b64_tr_b16 a[58:59], v104 offset:5120
    ds_read_b64_tr_b16 a[60:61], v105 offset:4096
    ds_read_b64_tr_b16 a[62:63], v105 offset:5120
    v_mfma_f32_32x32x16_bf16 v[48:63], a[24:27], v[84:87], v[48:63]
    v_mfma_f32_32x32x16_bf16 v[64:79], a[28:31], v[84:87], v[64:79]
    s_waitcnt lgkmcnt(0)
    v_mfma_f32_32x32x16_bf16 v[16:31], a[32:35], v[88:91], v[16:31]
    ds_read_b128 v[80:83], v100 offset:8192
    ds_read_b128 v[84:87], v101 offset:8192
    ds_read_b64_tr_b16 a[0:1], v102 offset:8192
    v_mfma_f32_32x32x16_bf16 v[32:47], a[36:39], v[88:91], v[32:47]
    ds_read_b64_tr_b16 a[2:3], v102 offset:9216
    ds_read_b64_tr_b16 a[4:5], v103 offset:8192
    ds_read_b64_tr_b16 a[6:7], v103 offset:9216
    v_mfma_f32_32x32x16_bf16 v[48:63], a[40:43], v[88:91], v[48:63]
    ds_read_b64_tr_b16 a[8:9], v104 offset:8192
    ds_read_b64_tr_b16 a[10:11], v104 offset:9216
    ds_read_b64_tr_b16 a[12:13], v105 offset:8192
    v_mfma_f32_32x32x16_bf16 v[64:79], a[44:47], v[88:91], v[64:79]
    ds_read_b64_tr_b16 a[14:15], v105 offset:9216
    ds_read_b64_tr_b16 a[16:17], v102 offset:12288
    ds_read_b64_tr_b16 a[18:19], v102 offset:13312
    v_mfma_f32_32x32x16_bf16 v[16:31], a[48:51], v[92:95], v[16:31]
    ds_read_b64_tr_b16 a[20:21], v103 offset:12288
    ds_read_b64_tr_b16 a[22:23], v103 offset:13312
    ds_read_b64_tr_b16 a[24:25], v104 offset:12288
    v_mfma_f32_32x32x16_bf16 v[32:47], a[52:55], v[92:95], v[32:47]
    ds_read_b64_tr_b16 a[26:27], v104 offset:13312
    ds_read_b64_tr_b16 a[28:29], v105 offset:12288
    ds_read_b64_tr_b16 a[30:31], v105 offset:13312
    v_mfma_f32_32x32x16_bf16 v[48:63], a[56:59], v[92:95], v[48:63]
    v_mfma_f32_32x32x16_bf16 v[64:79], a[60:63], v[92:95], v[64:79]
    s_barrier
    s_waitcnt lgkmcnt(0)
    v_mfma_f32_32x32x16_bf16 v[16:31], a[0:3], v[80:83], v[16:31]
    ds_read_b128 v[88:91], v100 offset:24576
    ds_read_b128 v[92:95], v101 offset:24576
    ds_read_b64_tr_b16 a[32:33], v96 offset:8192
    v_mfma_f32_32x32x16_bf16 v[32:47], a[4:7], v[80:83], v[32:47]
    ds_read_b64_tr_b16 a[34:35], v96 offset:9216
    ds_read_b64_tr_b16 a[36:37], v97 offset:8192
    ds_read_b64_tr_b16 a[38:39], v97 offset:9216
    v_mfma_f32_32x32x16_bf16 v[48:63], a[8:11], v[80:83], v[48:63]
    ds_read_b64_tr_b16 a[40:41], v98 offset:8192
    ds_read_b64_tr_b16 a[42:43], v98 offset:9216
    ds_read_b64_tr_b16 a[44:45], v99 offset:8192
    v_mfma_f32_32x32x16_bf16 v[64:79], a[12:15], v[80:83], v[64:79]
    ds_read_b64_tr_b16 a[46:47], v99 offset:9216
    ds_read_b64_tr_b16 a[48:49], v96 offset:12288
    ds_read_b64_tr_b16 a[50:51], v96 offset:13312
    v_mfma_f32_32x32x16_bf16 v[16:31], a[16:19], v[84:87], v[16:31]
    ds_read_b64_tr_b16 a[52:53], v97 offset:12288
    ds_read_b64_tr_b16 a[54:55], v97 offset:13312
    ds_read_b64_tr_b16 a[56:57], v98 offset:12288
    v_mfma_f32_32x32x16_bf16 v[32:47], a[20:23], v[84:87], v[32:47]
    ds_read_b64_tr_b16 a[58:59], v98 offset:13312
    ds_read_b64_tr_b16 a[60:61], v99 offset:12288
    ds_read_b64_tr_b16 a[62:63], v99 offset:13312
    v_mfma_f32_32x32x16_bf16 v[48:63], a[24:27], v[84:87], v[48:63]
    v_mfma_f32_32x32x16_bf16 v[64:79], a[28:31], v[84:87], v[64:79]
    s_waitcnt lgkmcnt(0)
    v_mfma_f32_32x32x16_bf16 v[16:31], a[32:35], v[88:91], v[16:31]
    ds_read_b128 v[80:83], v100 offset:32768
    ds_read_b128 v[84:87], v101 offset:32768
    ds_read_b64_tr_b16 a[0:1], v96 offset:16384
    v_mfma_f32_32x32x16_bf16 v[32:47], a[36:39], v[88:91], v[32:47]
    ds_read_b64_tr_b16 a[2:3], v96 offset:17408
    ds_read_b64_tr_b16 a[4:5], v97 offset:16384
    ds_read_b64_tr_b16 a[6:7], v97 offset:17408
    v_mfma_f32_32x32x16_bf16 v[48:63], a[40:43], v[88:91], v[48:63]
    ds_read_b64_tr_b16 a[8:9], v98 offset:16384
    ds_read_b64_tr_b16 a[10:11], v98 offset:17408
    ds_read_b64_tr_b16 a[12:13], v99 offset:16384
    v_mfma_f32_32x32x16_bf16 v[64:79], a[44:47], v[88:91], v[64:79]
    ds_read_b64_tr_b16 a[14:15], v99 offset:17408
    ds_read_b64_tr_b16 a[16:17], v96 offset:20480
    ds_read_b64_tr_b16 a[18:19], v96 offset:21504
    v_mfma_f32_32x32x16_bf16 v[16:31], a[48:51], v[92:95], v[16:31]
    ds_read_b64_tr_b16 a[20:21], v97 offset:20480
    ds_read_b64_tr_b16 a[22:23], v97 offset:21504
    ds_read_b64_tr_b16 a[24:25], v98 offset:20480
    v_mfma_f32_32x32x16_bf16 v[32:47], a[52:55], v[92:95], v[32:47]
    ds_read_b64_tr_b16 a[26:27], v98 offset:21504
    ds_read_b64_tr_b16 a[28:29], v99 offset:20480
    ds_read_b64_tr_b16 a[30:31], v99 offset:21504
    v_mfma_f32_32x32x16_bf16 v[48:63], a[56:59], v[92:95], v[48:63]
    v_mfma_f32_32x32x16_bf16 v[64:79], a[60:63], v[92:95], v[64:79]
    s_barrier
    s_waitcnt lgkmcnt(0)
    v_mfma_f32_32x32x16_bf16 v[16:31], a[0:3], v[80:83], v[16:31]
    ds_read_b128 v[88:91], v100 offset:40960
    ds_read_b128 v[92:95], v101 offset:40960
    ds_read_b64_tr_b16 a[32:33], v96 offset:24576
    v_mfma_f32_32x32x16_bf16 v[32:47], a[4:7], v[80:83], v[32:47]
    ds_read_b64_tr_b16 a[34:35], v96 offset:25600
    ds_read_b64_tr_b16 a[36:37], v97 offset:24576
    ds_read_b64_tr_b16 a[38:39], v97 offset:25600
    v_mfma_f32_32x32x16_bf16 v[48:63], a[8:11], v[80:83], v[48:63]
    ds_read_b64_tr_b16 a[40:41], v98 offset:24576
    ds_read_b64_tr_b16 a[42:43], v98 offset:25600
    ds_read_b64_tr_b16 a[44:45], v99 offset:24576
    v_mfma_f32_32x32x16_bf16 v[64:79], a[12:15], v[80:83], v[64:79]
    ds_read_b64_tr_b16 a[46:47], v99 offset:25600
    ds_read_b64_tr_b16 a[48:49], v96 offset:28672
    ds_read_b64_tr_b16 a[50:51], v96 offset:29696
    v_mfma_f32_32x32x16_bf16 v[16:31], a[16:19], v[84:87], v[16:31]
    ds_read_b64_tr_b16 a[52:53], v97 offset:28672
    ds_read_b64_tr_b16 a[54:55], v97 offset:29696
    ds_read_b64_tr_b16 a[56:57], v98 offset:28672
    v_mfma_f32_32x32x16_bf16 v[32:47], a[20:23], v[84:87], v[32:47]
    ds_read_b64_tr_b16 a[58:59], v98 offset:29696
    ds_read_b64_tr_b16 a[60:61], v99 offset:28672
    ds_read_b64_tr_b16 a[62:63], v99 offset:29696
    v_mfma_f32_32x32x16_bf16 v[48:63], a[24:27], v[84:87], v[48:63]
    v_mfma_f32_32x32x16_bf16 v[64:79], a[28:31], v[84:87], v[64:79]
    s_waitcnt lgkmcnt(0)
    v_mfma_f32_32x32x16_bf16 v[16:31], a[32:35], v[88:91], v[16:31]
    ds_read_b128 v[80:83], v100 offset:49152
    ds_read_b128 v[84:87], v101 offset:49152
    ds_read_b64_tr_b16 a[0:1], v96 offset:32768
    v_mfma_f32_32x32x16_bf16 v[32:47], a[36:39], v[88:91], v[32:47]
    ds_read_b64_tr_b16 a[2:3], v96 offset:33792
    ds_read_b64_tr_b16 a[4:5], v97 offset:32768
    ds_read_b64_tr_b16 a[6:7], v97 offset:33792
    v_mfma_f32_32x32x16_bf16 v[48:63], a[40:43], v[88:91], v[48:63]
    ds_read_b64_tr_b16 a[8:9], v98 offset:32768
    ds_read_b64_tr_b16 a[10:11], v98 offset:33792
    ds_read_b64_tr_b16 a[12:13], v99 offset:32768
    v_mfma_f32_32x32x16_bf16 v[64:79], a[44:47], v[88:91], v[64:79]
    ds_read_b64_tr_b16 a[14:15], v99 offset:33792
    ds_read_b64_tr_b16 a[16:17], v96 offset:36864
    ds_read_b64_tr_b16 a[18:19], v96 offset:37888
    v_mfma_f32_32x32x16_bf16 v[16:31], a[48:51], v[92:95], v[16:31]
    ds_read_b64_tr_b16 a[20:21], v97 offset:36864
    ds_read_b64_tr_b16 a[22:23], v97 offset:37888
    ds_read_b64_tr_b16 a[24:25], v98 offset:36864
    v_mfma_f32_32x32x16_bf16 v[32:47], a[52:55], v[92:95], v[32:47]
    ds_read_b64_tr_b16 a[26:27], v98 offset:37888
    ds_read_b64_tr_b16 a[28:29], v99 offset:36864
    ds_read_b64_tr_b16 a[30:31], v99 offset:37888
    v_mfma_f32_32x32x16_bf16 v[48:63], a[56:59], v[92:95], v[48:63]
    v_mfma_f32_32x32x16_bf16 v[64:79], a[60:63], v[92:95], v[64:79]
    s_barrier
    s_waitcnt lgkmcnt(0)
    v_mfma_f32_32x32x16_bf16 v[16:31], a[0:3], v[80:83], v[16:31]
    ds_read_b128 v[88:91], v100 offset:57344
    ds_read_b128 v[92:95], v101 offset:57344
    ds_read_b64_tr_b16 a[32:33], v96 offset:40960
    v_mfma_f32_32x32x16_bf16 v[32:47], a[4:7], v[80:83], v[32:47]
    ds_read_b64_tr_b16 a[34:35], v96 offset:41984
    ds_read_b64_tr_b16 a[36:37], v97 offset:40960
    ds_read_b64_tr_b16 a[38:39], v97 offset:41984
    v_mfma_f32_32x32x16_bf16 v[48:63], a[8:11], v[80:83], v[48:63]
    ds_read_b64_tr_b16 a[40:41], v98 offset:40960
    ds_read_b64_tr_b16 a[42:43], v98 offset:41984
    ds_read_b64_tr_b16 a[44:45], v99 offset:40960
    v_mfma_f32_32x32x16_bf16 v[64:79], a[12:15], v[80:83], v[64:79]
    ds_read_b64_tr_b16 a[46:47], v99 offset:41984
    ds_read_b64_tr_b16 a[48:49], v96 offset:45056
    ds_read_b64_tr_b16 a[50:51], v96 offset:46080
    v_mfma_f32_32x32x16_bf16 v[16:31], a[16:19], v[84:87], v[16:31]
    ds_read_b64_tr_b16 a[52:53], v97 offset:45056
    ds_read_b64_tr_b16 a[54:55], v97 offset:46080
    ds_read_b64_tr_b16 a[56:57], v98 offset:45056
    v_mfma_f32_32x32x16_bf16 v[32:47], a[20:23], v[84:87], v[32:47]
    ds_read_b64_tr_b16 a[58:59], v98 offset:46080
    ds_read_b64_tr_b16 a[60:61], v99 offset:45056
    ds_read_b64_tr_b16 a[62:63], v99 offset:46080
    v_mfma_f32_32x32x16_bf16 v[48:63], a[24:27], v[84:87], v[48:63]
    v_mfma_f32_32x32x16_bf16 v[64:79], a[28:31], v[84:87], v[64:79]
    s_waitcnt lgkmcnt(0)
    v_mfma_f32_32x32x16_bf16 v[16:31], a[32:35], v[88:91], v[16:31]
    ds_read_b128 v[80:83], v106 offset:0
    ds_read_b128 v[84:87], v107 offset:0
    ds_read_b64_tr_b16 a[0:1], v96 offset:49152
    v_mfma_f32_32x32x16_bf16 v[32:47], a[36:39], v[88:91], v[32:47]
    ds_read_b64_tr_b16 a[2:3], v96 offset:50176
    ds_read_b64_tr_b16 a[4:5], v97 offset:49152
    ds_read_b64_tr_b16 a[6:7], v97 offset:50176
    v_mfma_f32_32x32x16_bf16 v[48:63], a[40:43], v[88:91], v[48:63]
    ds_read_b64_tr_b16 a[8:9], v98 offset:49152
    ds_read_b64_tr_b16 a[10:11], v98 offset:50176
    ds_read_b64_tr_b16 a[12:13], v99 offset:49152
    v_mfma_f32_32x32x16_bf16 v[64:79], a[44:47], v[88:91], v[64:79]
    ds_read_b64_tr_b16 a[14:15], v99 offset:50176
    ds_read_b64_tr_b16 a[16:17], v96 offset:53248
    ds_read_b64_tr_b16 a[18:19], v96 offset:54272
    v_mfma_f32_32x32x16_bf16 v[16:31], a[48:51], v[92:95], v[16:31]
    ds_read_b64_tr_b16 a[20:21], v97 offset:53248
    ds_read_b64_tr_b16 a[22:23], v97 offset:54272
    ds_read_b64_tr_b16 a[24:25], v98 offset:53248
    v_mfma_f32_32x32x16_bf16 v[32:47], a[52:55], v[92:95], v[32:47]
    ds_read_b64_tr_b16 a[26:27], v98 offset:54272
    ds_read_b64_tr_b16 a[28:29], v99 offset:53248
    ds_read_b64_tr_b16 a[30:31], v99 offset:54272
    v_mfma_f32_32x32x16_bf16 v[48:63], a[56:59], v[92:95], v[48:63]
    v_mfma_f32_32x32x16_bf16 v[64:79], a[60:63], v[92:95], v[64:79]
    s_barrier
    s_waitcnt lgkmcnt(0)
    v_mfma_f32_32x32x16_bf16 v[16:31], a[0:3], v[80:83], v[16:31]
    ds_read_b128 v[88:91], v106 offset:8192
    ds_read_b128 v[92:95], v107 offset:8192
    ds_read_b64_tr_b16 a[32:33], v96 offset:57344
    v_mfma_f32_32x32x16_bf16 v[32:47], a[4:7], v[80:83], v[32:47]
    ds_read_b64_tr_b16 a[34:35], v96 offset:58368
    ds_read_b64_tr_b16 a[36:37], v97 offset:57344
    ds_read_b64_tr_b16 a[38:39], v97 offset:58368
    v_mfma_f32_32x32x16_bf16 v[48:63], a[8:11], v[80:83], v[48:63]
    ds_read_b64_tr_b16 a[40:41], v98 offset:57344
    ds_read_b64_tr_b16 a[42:43], v98 offset:58368
    ds_read_b64_tr_b16 a[44:45], v99 offset:57344
    v_mfma_f32_32x32x16_bf16 v[64:79], a[12:15], v[80:83], v[64:79]
    ds_read_b64_tr_b16 a[46:47], v99 offset:58368
    ds_read_b64_tr_b16 a[48:49], v96 offset:61440
    ds_read_b64_tr_b16 a[50:51], v96 offset:62464
    v_mfma_f32_32x32x16_bf16 v[16:31], a[16:19], v[84:87], v[16:31]
    ds_read_b64_tr_b16 a[52:53], v97 offset:61440
    ds_read_b64_tr_b16 a[54:55], v97 offset:62464
    ds_read_b64_tr_b16 a[56:57], v98 offset:61440
    v_mfma_f32_32x32x16_bf16 v[32:47], a[20:23], v[84:87], v[32:47]
    ds_read_b64_tr_b16 a[58:59], v98 offset:62464
    ds_read_b64_tr_b16 a[60:61], v99 offset:61440
    ds_read_b64_tr_b16 a[62:63], v99 offset:62464
    v_mfma_f32_32x32x16_bf16 v[48:63], a[24:27], v[84:87], v[48:63]
    v_mfma_f32_32x32x16_bf16 v[64:79], a[28:31], v[84:87], v[64:79]
    s_waitcnt lgkmcnt(0)
    v_mfma_f32_32x32x16_bf16 v[16:31], a[32:35], v[88:91], v[16:31]
    ds_read_b128 v[80:83], v100 offset:0
    ds_read_b128 v[84:87], v101 offset:0
    ds_read_b64_tr_b16 a[0:1], v102 offset:0
    v_mfma_f32_32x32x16_bf16 v[32:47], a[36:39], v[88:91], v[32:47]
    ds_read_b64_tr_b16 a[2:3], v102 offset:1024
    ds_read_b64_tr_b16 a[4:5], v103 offset:0
    ds_read_b64_tr_b16 a[6:7], v103 offset:1024
    v_mfma_f32_32x32x16_bf16 v[48:63], a[40:43], v[88:91], v[48:63]
    ds_read_b64_tr_b16 a[8:9], v104 offset:0
    ds_read_b64_tr_b16 a[10:11], v104 offset:1024
    ds_read_b64_tr_b16 a[12:13], v105 offset:0
    v_mfma_f32_32x32x16_bf16 v[64:79], a[44:47], v[88:91], v[64:79]
    ds_read_b64_tr_b16 a[14:15], v105 offset:1024
    ds_read_b64_tr_b16 a[16:17], v102 offset:4096
    ds_read_b64_tr_b16 a[18:19], v102 offset:5120
    v_mfma_f32_32x32x16_bf16 v[16:31], a[48:51], v[92:95], v[16:31]
    ds_read_b64_tr_b16 a[20:21], v103 offset:4096
    ds_read_b64_tr_b16 a[22:23], v103 offset:5120
    ds_read_b64_tr_b16 a[24:25], v104 offset:4096
    v_mfma_f32_32x32x16_bf16 v[32:47], a[52:55], v[92:95], v[32:47]
    ds_read_b64_tr_b16 a[26:27], v104 offset:5120
    ds_read_b64_tr_b16 a[28:29], v105 offset:4096
    ds_read_b64_tr_b16 a[30:31], v105 offset:5120
    v_mfma_f32_32x32x16_bf16 v[48:63], a[56:59], v[92:95], v[48:63]
    v_mfma_f32_32x32x16_bf16 v[64:79], a[60:63], v[92:95], v[64:79]
    s_barrier
    s_waitcnt lgkmcnt(0)
    v_mfma_f32_32x32x16_bf16 v[16:31], a[0:3], v[80:83], v[16:31]
    ds_read_b128 v[88:91], v100 offset:8192
    ds_read_b128 v[92:95], v101 offset:8192
    ds_read_b64_tr_b16 a[32:33], v102 offset:8192
    v_mfma_f32_32x32x16_bf16 v[32:47], a[4:7], v[80:83], v[32:47]
    ds_read_b64_tr_b16 a[34:35], v102 offset:9216
    ds_read_b64_tr_b16 a[36:37], v103 offset:8192
    ds_read_b64_tr_b16 a[38:39], v103 offset:9216
    v_mfma_f32_32x32x16_bf16 v[48:63], a[8:11], v[80:83], v[48:63]
    ds_read_b64_tr_b16 a[40:41], v104 offset:8192
    ds_read_b64_tr_b16 a[42:43], v104 offset:9216
    ds_read_b64_tr_b16 a[44:45], v105 offset:8192
    v_mfma_f32_32x32x16_bf16 v[64:79], a[12:15], v[80:83], v[64:79]
    ds_read_b64_tr_b16 a[46:47], v105 offset:9216
    ds_read_b64_tr_b16 a[48:49], v102 offset:12288
    ds_read_b64_tr_b16 a[50:51], v102 offset:13312
    v_mfma_f32_32x32x16_bf16 v[16:31], a[16:19], v[84:87], v[16:31]
    ds_read_b64_tr_b16 a[52:53], v103 offset:12288
    ds_read_b64_tr_b16 a[54:55], v103 offset:13312
    ds_read_b64_tr_b16 a[56:57], v104 offset:12288
    v_mfma_f32_32x32x16_bf16 v[32:47], a[20:23], v[84:87], v[32:47]
    ds_read_b64_tr_b16 a[58:59], v104 offset:13312
    ds_read_b64_tr_b16 a[60:61], v105 offset:12288
    ds_read_b64_tr_b16 a[62:63], v105 offset:13312
    v_mfma_f32_32x32x16_bf16 v[48:63], a[24:27], v[84:87], v[48:63]
    v_mfma_f32_32x32x16_bf16 v[64:79], a[28:31], v[84:87], v[64:79]
    s_waitcnt lgkmcnt(0)
    v_mfma_f32_32x32x16_bf16 v[16:31], a[32:35], v[88:91], v[16:31]
    v_mfma_f32_32x32x16_bf16 v[32:47], a[36:39], v[88:91], v[32:47]
    v_mfma_f32_32x32x16_bf16 v[48:63], a[40:43], v[88:91], v[48:63]
    v_mfma_f32_32x32x16_bf16 v[64:79], a[44:47], v[88:91], v[64:79]
    v_mfma_f32_32x32x16_bf16 v[16:31], a[48:51], v[92:95], v[16:31]
    v_mfma_f32_32x32x16_bf16 v[32:47], a[52:55], v[92:95], v[32:47]
    v_mfma_f32_32x32x16_bf16 v[48:63], a[56:59], v[92:95], v[48:63]
    v_mfma_f32_32x32x16_bf16 v[64:79], a[60:63], v[92:95], v[64:79]
    s_barrier
    ds_read_b128 a[0:3], v4 offset:0
    ds_read_b128 a[4:7], v5 offset:0
    ds_read_b128 a[8:11], v6 offset:0
    ds_read_b128 a[12:15], v7 offset:0
    ds_read_b128 a[16:19], v8 offset:0
    ds_read_b128 a[20:23], v9 offset:0
    ds_read_b128 a[24:27], v10 offset:0
    ds_read_b128 a[28:31], v11 offset:0
    v_mov_b32 v80, 0x3e0293ee
    v_mov_b32 v81, 0x3e0293ee
    s_nop 3
    v_pk_mul_f32 v[16:17], v[16:17], v[80:81]
    v_pk_mul_f32 v[18:19], v[18:19], v[80:81]
    v_pk_mul_f32 v[20:21], v[20:21], v[80:81]
    v_pk_mul_f32 v[22:23], v[22:23], v[80:81]
    v_cvt_pk_bf16_f32 v96, v16, v17
    v_cvt_pk_bf16_f32 v97, v18, v19
    v_cvt_pk_bf16_f32 v98, v20, v21
    v_cvt_pk_bf16_f32 v99, v22, v23
    v_pk_mul_f32 v[24:25], v[24:25], v[80:81]
    v_pk_mul_f32 v[26:27], v[26:27], v[80:81]
    v_pk_mul_f32 v[28:29], v[28:29], v[80:81]
    v_pk_mul_f32 v[30:31], v[30:31], v[80:81]
    v_cvt_pk_bf16_f32 v100, v24, v25
    v_cvt_pk_bf16_f32 v101, v26, v27
    v_cvt_pk_bf16_f32 v102, v28, v29
    v_cvt_pk_bf16_f32 v103, v30, v31
    v_mov_b32 v3, 0
    s_waitcnt lgkmcnt(0)
    v_mfma_f32_32x32x16_bf16 v[16:31], a[0:3], v[96:99], 0
    s_barrier
    ds_read_b128 a[0:3], v4 offset:8192
    v_pk_mul_f32 v[32:33], v[32:33], v[80:81]
    v_pk_mul_f32 v[34:35], v[34:35], v[80:81]
    v_pk_mul_f32 v[36:37], v[36:37], v[80:81]
    v_pk_mul_f32 v[38:39], v[38:39], v[80:81]
    v_cvt_pk_bf16_f32 v104, v32, v33
    v_cvt_pk_bf16_f32 v105, v34, v35
    v_cvt_pk_bf16_f32 v106, v36, v37
    v_cvt_pk_bf16_f32 v107, v38, v39
    v_mfma_f32_32x32x16_bf16 v[16:31], a[4:7], v[100:103], v[16:31]
    ds_read_b128 a[4:7], v5 offset:8192
    ds_read_b64_tr_b16 a[32:33], v12 offset:0
    v_pk_mul_f32 v[40:41], v[40:41], v[80:81]
    v_pk_mul_f32 v[42:43], v[42:43], v[80:81]
    v_pk_mul_f32 v[44:45], v[44:45], v[80:81]
    v_pk_mul_f32 v[46:47], v[46:47], v[80:81]
    v_cvt_pk_bf16_f32 v108, v40, v41
    v_cvt_pk_bf16_f32 v109, v42, v43
    v_cvt_pk_bf16_f32 v110, v44, v45
    v_cvt_pk_bf16_f32 v111, v46, v47
    v_mfma_f32_32x32x16_bf16 v[16:31], a[8:11], v[104:107], v[16:31]
    ds_read_b128 a[8:11], v6 offset:8192
    v_pk_mul_f32 v[48:49], v[48:49], v[80:81]
    v_pk_mul_f32 v[50:51], v[50:51], v[80:81]
    v_pk_mul_f32 v[52:53], v[52:53], v[80:81]
    v_pk_mul_f32 v[54:55], v[54:55], v[80:81]
    v_cvt_pk_bf16_f32 v112, v48, v49
    v_cvt_pk_bf16_f32 v113, v50, v51
    v_cvt_pk_bf16_f32 v114, v52, v53
    v_cvt_pk_bf16_f32 v115, v54, v55
    v_mfma_f32_32x32x16_bf16 v[16:31], a[12:15], v[108:111], v[16:31]
    ds_read_b128 a[12:15], v7 offset:8192
    ds_read_b64_tr_b16 a[34:35], v12 offset:2048
    v_pk_mul_f32 v[56:57], v[56:57], v[80:81]
    v_pk_mul_f32 v[58:59], v[58:59], v[80:81]
    v_pk_mul_f32 v[60:61], v[60:61], v[80:81]
    v_pk_mul_f32 v[62:63], v[62:63], v[80:81]
    v_cvt_pk_bf16_f32 v116, v56, v57
    v_cvt_pk_bf16_f32 v117, v58, v59
    v_cvt_pk_bf16_f32 v118, v60, v61
    v_cvt_pk_bf16_f32 v119, v62, v63
    v_mfma_f32_32x32x16_bf16 v[16:31], a[16:19], v[112:115], v[16:31]
    ds_read_b128 a[16:19], v8 offset:8192
    ds_read_b64_tr_b16 a[36:37], v13 offset:0
    v_pk_mul_f32 v[64:65], v[64:65], v[80:81]
    v_pk_mul_f32 v[66:67], v[66:67], v[80:81]
    v_pk_mul_f32 v[68:69], v[68:69], v[80:81]
    v_pk_mul_f32 v[70:71], v[70:71], v[80:81]
    v_cvt_pk_bf16_f32 v120, v64, v65
    v_cvt_pk_bf16_f32 v121, v66, v67
    v_cvt_pk_bf16_f32 v122, v68, v69
    v_cvt_pk_bf16_f32 v123, v70, v71
    v_mfma_f32_32x32x16_bf16 v[16:31], a[20:23], v[116:119], v[16:31]
    ds_read_b128 a[20:23], v9 offset:8192
    ds_read_b64_tr_b16 a[38:39], v13 offset:2048
    v_pk_mul_f32 v[72:73], v[72:73], v[80:81]
    v_pk_mul_f32 v[74:75], v[74:75], v[80:81]
    v_pk_mul_f32 v[76:77], v[76:77], v[80:81]
    v_pk_mul_f32 v[78:79], v[78:79], v[80:81]
    v_cvt_pk_bf16_f32 v124, v72, v73
    v_cvt_pk_bf16_f32 v125, v74, v75
    v_cvt_pk_bf16_f32 v126, v76, v77
    v_cvt_pk_bf16_f32 v127, v78, v79
    v_mfma_f32_32x32x16_bf16 v[16:31], a[24:27], v[120:123], v[16:31]
    ds_read_b128 a[24:27], v10 offset:8192
    ds_read_b64_tr_b16 a[40:41], v14 offset:0
    v_mfma_f32_32x32x16_bf16 v[16:31], a[28:31], v[124:127], v[16:31]
    ds_read_b128 a[28:31], v11 offset:8192
    ds_read_b64_tr_b16 a[42:43], v14 offset:2048
    ds_read_b64_tr_b16 a[44:45], v15 offset:0
    ds_read_b64_tr_b16 a[46:47], v15 offset:2048
    ds_read_b64_tr_b16 a[48:49], v12 offset:4096
    s_nop 7
    s_nop 3
    ds_read_b64_tr_b16 a[50:51], v12 offset:6144
    v_exp_f32 v16, v16
    ds_read_b64_tr_b16 a[52:53], v13 offset:4096
    ds_read_b64_tr_b16 a[54:55], v13 offset:6144
    v_exp_f32 v17, v17
    v_add_f32 v3, v3, v16
    ds_read_b64_tr_b16 a[56:57], v14 offset:4096
    v_exp_f32 v18, v18
    v_add_f32 v3, v3, v17
    v_cvt_pk_bf16_f32 v80, v16, v17
    ds_read_b64_tr_b16 a[58:59], v14 offset:6144
    ds_read_b64_tr_b16 a[60:61], v15 offset:4096
    v_exp_f32 v19, v19
    v_add_f32 v3, v3, v18
    ds_read_b64_tr_b16 a[62:63], v15 offset:6144
    v_exp_f32 v20, v20
    v_add_f32 v3, v3, v19
    v_cvt_pk_bf16_f32 v81, v18, v19
    v_exp_f32 v21, v21
    v_add_f32 v3, v3, v20
    v_add_f32 v3, v3, v21
    v_cvt_pk_bf16_f32 v82, v20, v21
    s_mov_b32 s30, 0
L_p2loop:
    s_waitcnt lgkmcnt(11)
    v_mfma_f32_32x32x16_bf16 v[32:47], a[0:3], v[96:99], 0
    s_barrier
    ds_read_b128 a[0:3], v4 offset:16384
    v_mfma_f32_32x32x16_bf16 v[32:47], a[4:7], v[100:103], v[32:47]
    ds_read_b128 a[4:7], v5 offset:16384
    ds_read_b64_tr_b16 v[48:49], v12 offset:8192
    v_exp_f32 v22, v22
    v_exp_f32 v23, v23
    v_mfma_f32_32x32x16_bf16 v[32:47], a[8:11], v[104:107], v[32:47]
    ds_read_b128 a[8:11], v6 offset:16384
    v_exp_f32 v24, v24
    v_add_f32 v3, v3, v22
    v_add_f32 v3, v3, v23
    v_cvt_pk_bf16_f32 v83, v22, v23
    v_mfma_f32_32x32x16_bf16 v[32:47], a[12:15], v[108:111], v[32:47]
    ds_read_b128 a[12:15], v7 offset:16384
    ds_read_b64_tr_b16 v[50:51], v12 offset:10240
    v_exp_f32 v25, v25
    v_add_f32 v3, v3, v24
    v_mfma_f32_32x32x16_bf16 v[32:47], a[16:19], v[112:115], v[32:47]
    ds_read_b128 a[16:19], v8 offset:16384
    ds_read_b64_tr_b16 v[52:53], v13 offset:8192
    v_exp_f32 v26, v26
    v_add_f32 v3, v3, v25
    v_cvt_pk_bf16_f32 v84, v24, v25
    v_mfma_f32_32x32x16_bf16 v[32:47], a[20:23], v[116:119], v[32:47]
    ds_read_b128 a[20:23], v9 offset:16384
    ds_read_b64_tr_b16 v[54:55], v13 offset:10240
    v_exp_f32 v27, v27
    v_add_f32 v3, v3, v26
    v_mfma_f32_32x32x16_bf16 v[32:47], a[24:27], v[120:123], v[32:47]
    ds_read_b128 a[24:27], v10 offset:16384
    ds_read_b64_tr_b16 v[56:57], v14 offset:8192
    v_exp_f32 v28, v28
    v_add_f32 v3, v3, v27
    v_cvt_pk_bf16_f32 v85, v26, v27
    v_mfma_f32_32x32x16_bf16 v[32:47], a[28:31], v[124:127], v[32:47]
    ds_read_b128 a[28:31], v11 offset:16384
    ds_read_b64_tr_b16 v[58:59], v14 offset:10240
    v_exp_f32 v29, v29
    v_add_f32 v3, v3, v28
    s_waitcnt lgkmcnt(14)
    v_mfma_f32_32x32x16_bf16 v[128:143], a[32:35], v[80:83], v[128:143]
    ds_read_b64_tr_b16 v[60:61], v15 offset:8192
    v_exp_f32 v30, v30
    v_add_f32 v3, v3, v29
    v_cvt_pk_bf16_f32 v86, v28, v29
    v_mfma_f32_32x32x16_bf16 v[144:159], a[36:39], v[80:83], v[144:159]
    ds_read_b64_tr_b16 v[62:63], v15 offset:10240
    ds_read_b64_tr_b16 v[64:65], v12 offset:12288
    v_exp_f32 v31, v31
    v_add_f32 v3, v3, v30
    v_mfma_f32_32x32x16_bf16 v[160:175], a[40:43], v[80:83], v[160:175]
    ds_read_b64_tr_b16 v[66:67], v12 offset:14336
    v_exp_f32 v32, v32
    v_add_f32 v3, v3, v31
    v_cvt_pk_bf16_f32 v87, v30, v31
    v_mfma_f32_32x32x16_bf16 v[176:191], a[44:47], v[80:83], v[176:191]
    ds_read_b64_tr_b16 v[68:69], v13 offset:12288
    ds_read_b64_tr_b16 v[70:71], v13 offset:14336
    v_exp_f32 v33, v33
    v_add_f32 v3, v3, v32
    v_mfma_f32_32x32x16_bf16 v[128:143], a[48:51], v[84:87], v[128:143]
    ds_read_b64_tr_b16 v[72:73], v14 offset:12288
    v_exp_f32 v34, v34
    v_add_f32 v3, v3, v33
    v_cvt_pk_bf16_f32 v88, v32, v33
    v_mfma_f32_32x32x16_bf16 v[144:159], a[52:55], v[84:87], v[144:159]
    ds_read_b64_tr_b16 v[74:75], v14 offset:14336
    ds_read_b64_tr_b16 v[76:77], v15 offset:12288
    v_exp_f32 v35, v35
    v_add_f32 v3, v3, v34
    v_mfma_f32_32x32x16_bf16 v[160:175], a[56:59], v[84:87], v[160:175]
    ds_read_b64_tr_b16 v[78:79], v15 offset:14336
    v_exp_f32 v36, v36
    v_add_f32 v3, v3, v35
    v_cvt_pk_bf16_f32 v89, v34, v35
    v_mfma_f32_32x32x16_bf16 v[176:191], a[60:63], v[84:87], v[176:191]
    v_exp_f32 v37, v37
    v_add_f32 v3, v3, v36
    v_add_f32 v3, v3, v37
    v_cvt_pk_bf16_f32 v90, v36, v37
    s_waitcnt lgkmcnt(11)
    v_mfma_f32_32x32x16_bf16 v[16:31], a[0:3], v[96:99], 0
    s_barrier
    ds_read_b128 a[0:3], v4 offset:24576
    v_mfma_f32_32x32x16_bf16 v[16:31], a[4:7], v[100:103], v[16:31]
    ds_read_b128 a[4:7], v5 offset:24576
    ds_read_b64_tr_b16 a[32:33], v12 offset:16384
    v_exp_f32 v38, v38
    v_exp_f32 v39, v39
    v_mfma_f32_32x32x16_bf16 v[16:31], a[8:11], v[104:107], v[16:31]
    ds_read_b128 a[8:11], v6 offset:24576
    v_exp_f32 v40, v40
    v_add_f32 v3, v3, v38
    v_add_f32 v3, v3, v39
    v_cvt_pk_bf16_f32 v91, v38, v39
    v_mfma_f32_32x32x16_bf16 v[16:31], a[12:15], v[108:111], v[16:31]
    ds_read_b128 a[12:15], v7 offset:24576
    ds_read_b64_tr_b16 a[34:35], v12 offset:18432
    v_exp_f32 v41, v41
    v_add_f32 v3, v3, v40
    v_mfma_f32_32x32x16_bf16 v[16:31], a[16:19], v[112:115], v[16:31]
    ds_read_b128 a[16:19], v8 offset:24576
    ds_read_b64_tr_b16 a[36:37], v13 offset:16384
    v_exp_f32 v42, v42
    v_add_f32 v3, v3, v41
    v_cvt_pk_bf16_f32 v92, v40, v41
    v_mfma_f32_32x32x16_bf16 v[16:31], a[20:23], v[116:119], v[16:31]
    ds_read_b128 a[20:23], v9 offset:24576
    ds_read_b64_tr_b16 a[38:39], v13 offset:18432
    v_exp_f32 v43, v43
    v_add_f32 v3, v3, v42
    v_mfma_f32_32x32x16_bf16 v[16:31], a[24:27], v[120:123], v[16:31]
    ds_read_b128 a[24:27], v10 offset:24576
    ds_read_b64_tr_b16 a[40:41], v14 offset:16384
    v_exp_f32 v44, v44
    v_add_f32 v3, v3, v43
    v_cvt_pk_bf16_f32 v93, v42, v43
    v_mfma_f32_32x32x16_bf16 v[16:31], a[28:31], v[124:127], v[16:31]
    ds_read_b128 a[28:31], v11 offset:24576
    ds_read_b64_tr_b16 a[42:43], v14 offset:18432
    v_exp_f32 v45, v45
    v_add_f32 v3, v3, v44
    s_waitcnt lgkmcnt(14)
    v_mfma_f32_32x32x16_bf16 v[128:143], v[48:51], v[88:91], v[128:143]
    ds_read_b64_tr_b16 a[44:45], v15 offset:16384
    v_exp_f32 v46, v46
    v_add_f32 v3, v3, v45
    v_cvt_pk_bf16_f32 v94, v44, v45
    v_mfma_f32_32x32x16_bf16 v[144:159], v[52:55], v[88:91], v[144:159]
    ds_read_b64_tr_b16 a[46:47], v15 offset:18432
    ds_read_b64_tr_b16 a[48:49], v12 offset:20480
    v_exp_f32 v47, v47
    v_add_f32 v3, v3, v46
    v_mfma_f32_32x32x16_bf16 v[160:175], v[56:59], v[88:91], v[160:175]
    ds_read_b64_tr_b16 a[50:51], v12 offset:22528
    v_exp_f32 v16, v16
    v_add_f32 v3, v3, v47
    v_cvt_pk_bf16_f32 v95, v46, v47
    v_mfma_f32_32x32x16_bf16 v[176:191], v[60:63], v[88:91], v[176:191]
    ds_read_b64_tr_b16 a[52:53], v13 offset:20480
    ds_read_b64_tr_b16 a[54:55], v13 offset:22528
    v_exp_f32 v17, v17
    v_add_f32 v3, v3, v16
    v_mfma_f32_32x32x16_bf16 v[128:143], v[64:67], v[92:95], v[128:143]
    ds_read_b64_tr_b16 a[56:57], v14 offset:20480
    v_exp_f32 v18, v18
    v_add_f32 v3, v3, v17
    v_cvt_pk_bf16_f32 v80, v16, v17
    v_mfma_f32_32x32x16_bf16 v[144:159], v[68:71], v[92:95], v[144:159]
    ds_read_b64_tr_b16 a[58:59], v14 offset:22528
    ds_read_b64_tr_b16 a[60:61], v15 offset:20480
    v_exp_f32 v19, v19
    v_add_f32 v3, v3, v18
    v_mfma_f32_32x32x16_bf16 v[160:175], v[72:75], v[92:95], v[160:175]
    ds_read_b64_tr_b16 a[62:63], v15 offset:22528
    v_exp_f32 v20, v20
    v_add_f32 v3, v3, v19
    v_cvt_pk_bf16_f32 v81, v18, v19
    v_mfma_f32_32x32x16_bf16 v[176:191], v[76:79], v[92:95], v[176:191]
    v_exp_f32 v21, v21
    v_add_f32 v3, v3, v20
    v_add_f32 v3, v3, v21
    v_cvt_pk_bf16_f32 v82, v20, v21
    s_waitcnt lgkmcnt(11)
    v_mfma_f32_32x32x16_bf16 v[32:47], a[0:3], v[96:99], 0
    s_barrier
    ds_read_b128 a[0:3], v4 offset:32768
    v_mfma_f32_32x32x16_bf16 v[32:47], a[4:7], v[100:103], v[32:47]
    ds_read_b128 a[4:7], v5 offset:32768
    ds_read_b64_tr_b16 v[48:49], v12 offset:24576
    v_exp_f32 v22, v22
    v_exp_f32 v23, v23
    v_mfma_f32_32x32x16_bf16 v[32:47], a[8:11], v[104:107], v[32:47]
    ds_read_b128 a[8:11], v6 offset:32768
    v_exp_f32 v24, v24
    v_add_f32 v3, v3, v22
    v_add_f32 v3, v3, v23
    v_cvt_pk_bf16_f32 v83, v22, v23
    v_mfma_f32_32x32x16_bf16 v[32:47], a[12:15], v[108:111], v[32:47]
    ds_read_b128 a[12:15], v7 offset:32768
    ds_read_b64_tr_b16 v[50:51], v12 offset:26624
    v_exp_f32 v25, v25
    v_add_f32 v3, v3, v24
    v_mfma_f32_32x32x16_bf16 v[32:47], a[16:19], v[112:115], v[32:47]
    ds_read_b128 a[16:19], v8 offset:32768
    ds_read_b64_tr_b16 v[52:53], v13 offset:24576
    v_exp_f32 v26, v26
    v_add_f32 v3, v3, v25
    v_cvt_pk_bf16_f32 v84, v24, v25
    v_mfma_f32_32x32x16_bf16 v[32:47], a[20:23], v[116:119], v[32:47]
    ds_read_b128 a[20:23], v9 offset:32768
    ds_read_b64_tr_b16 v[54:55], v13 offset:26624
    v_exp_f32 v27, v27
    v_add_f32 v3, v3, v26
    v_mfma_f32_32x32x16_bf16 v[32:47], a[24:27], v[120:123], v[32:47]
    ds_read_b128 a[24:27], v10 offset:32768
    ds_read_b64_tr_b16 v[56:57], v14 offset:24576
    v_exp_f32 v28, v28
    v_add_f32 v3, v3, v27
    v_cvt_pk_bf16_f32 v85, v26, v27
    v_mfma_f32_32x32x16_bf16 v[32:47], a[28:31], v[124:127], v[32:47]
    ds_read_b128 a[28:31], v11 offset:32768
    ds_read_b64_tr_b16 v[58:59], v14 offset:26624
    v_exp_f32 v29, v29
    v_add_f32 v3, v3, v28
    s_waitcnt lgkmcnt(14)
    v_mfma_f32_32x32x16_bf16 v[128:143], a[32:35], v[80:83], v[128:143]
    ds_read_b64_tr_b16 v[60:61], v15 offset:24576
    v_exp_f32 v30, v30
    v_add_f32 v3, v3, v29
    v_cvt_pk_bf16_f32 v86, v28, v29
    v_mfma_f32_32x32x16_bf16 v[144:159], a[36:39], v[80:83], v[144:159]
    ds_read_b64_tr_b16 v[62:63], v15 offset:26624
    ds_read_b64_tr_b16 v[64:65], v12 offset:28672
    v_exp_f32 v31, v31
    v_add_f32 v3, v3, v30
    v_mfma_f32_32x32x16_bf16 v[160:175], a[40:43], v[80:83], v[160:175]
    ds_read_b64_tr_b16 v[66:67], v12 offset:30720
    v_exp_f32 v32, v32
    v_add_f32 v3, v3, v31
    v_cvt_pk_bf16_f32 v87, v30, v31
    v_mfma_f32_32x32x16_bf16 v[176:191], a[44:47], v[80:83], v[176:191]
    ds_read_b64_tr_b16 v[68:69], v13 offset:28672
    ds_read_b64_tr_b16 v[70:71], v13 offset:30720
    v_exp_f32 v33, v33
    v_add_f32 v3, v3, v32
    v_mfma_f32_32x32x16_bf16 v[128:143], a[48:51], v[84:87], v[128:143]
    ds_read_b64_tr_b16 v[72:73], v14 offset:28672
    v_exp_f32 v34, v34
    v_add_f32 v3, v3, v33
    v_cvt_pk_bf16_f32 v88, v32, v33
    v_mfma_f32_32x32x16_bf16 v[144:159], a[52:55], v[84:87], v[144:159]
    ds_read_b64_tr_b16 v[74:75], v14 offset:30720
    ds_read_b64_tr_b16 v[76:77], v15 offset:28672
    v_exp_f32 v35, v35
    v_add_f32 v3, v3, v34
    v_mfma_f32_32x32x16_bf16 v[160:175], a[56:59], v[84:87], v[160:175]
    ds_read_b64_tr_b16 v[78:79], v15 offset:30720
    v_exp_f32 v36, v36
    v_add_f32 v3, v3, v35
    v_cvt_pk_bf16_f32 v89, v34, v35
    v_mfma_f32_32x32x16_bf16 v[176:191], a[60:63], v[84:87], v[176:191]
    v_exp_f32 v37, v37
    v_add_f32 v3, v3, v36
    v_add_f32 v3, v3, v37
    v_cvt_pk_bf16_f32 v90, v36, v37
    s_waitcnt lgkmcnt(11)
    v_mfma_f32_32x32x16_bf16 v[16:31], a[0:3], v[96:99], 0
    s_barrier
    ds_read_b128 a[0:3], v4 offset:40960
    v_mfma_f32_32x32x16_bf16 v[16:31], a[4:7], v[100:103], v[16:31]
    ds_read_b128 a[4:7], v5 offset:40960
    ds_read_b64_tr_b16 a[32:33], v12 offset:32768
    v_exp_f32 v38, v38
    v_exp_f32 v39, v39
    v_mfma_f32_32x32x16_bf16 v[16:31], a[8:11], v[104:107], v[16:31]
    ds_read_b128 a[8:11], v6 offset:40960
    v_exp_f32 v40, v40
    v_add_f32 v3, v3, v38
    v_add_f32 v3, v3, v39
    v_cvt_pk_bf16_f32 v91, v38, v39
    v_mfma_f32_32x32x16_bf16 v[16:31], a[12:15], v[108:111], v[16:31]
    ds_read_b128 a[12:15], v7 offset:40960
    ds_read_b64_tr_b16 a[34:35], v12 offset:34816
    v_exp_f32 v41, v41
    v_add_f32 v3, v3, v40
    v_mfma_f32_32x32x16_bf16 v[16:31], a[16:19], v[112:115], v[16:31]
    ds_read_b128 a[16:19], v8 offset:40960
    ds_read_b64_tr_b16 a[36:37], v13 offset:32768
    v_exp_f32 v42, v42
    v_add_f32 v3, v3, v41
    v_cvt_pk_bf16_f32 v92, v40, v41
    v_mfma_f32_32x32x16_bf16 v[16:31], a[20:23], v[116:119], v[16:31]
    ds_read_b128 a[20:23], v9 offset:40960
    ds_read_b64_tr_b16 a[38:39], v13 offset:34816
    v_exp_f32 v43, v43
    v_add_f32 v3, v3, v42
    v_mfma_f32_32x32x16_bf16 v[16:31], a[24:27], v[120:123], v[16:31]
    ds_read_b128 a[24:27], v10 offset:40960
    ds_read_b64_tr_b16 a[40:41], v14 offset:32768
    v_exp_f32 v44, v44
    v_add_f32 v3, v3, v43
    v_cvt_pk_bf16_f32 v93, v42, v43
    v_mfma_f32_32x32x16_bf16 v[16:31], a[28:31], v[124:127], v[16:31]
    ds_read_b128 a[28:31], v11 offset:40960
    ds_read_b64_tr_b16 a[42:43], v14 offset:34816
    v_exp_f32 v45, v45
    v_add_f32 v3, v3, v44
    s_waitcnt lgkmcnt(14)
    v_mfma_f32_32x32x16_bf16 v[128:143], v[48:51], v[88:91], v[128:143]
    ds_read_b64_tr_b16 a[44:45], v15 offset:32768
    v_exp_f32 v46, v46
    v_add_f32 v3, v3, v45
    v_cvt_pk_bf16_f32 v94, v44, v45
    v_mfma_f32_32x32x16_bf16 v[144:159], v[52:55], v[88:91], v[144:159]
    ds_read_b64_tr_b16 a[46:47], v15 offset:34816
    ds_read_b64_tr_b16 a[48:49], v12 offset:36864
    v_exp_f32 v47, v47
    v_add_f32 v3, v3, v46
    v_mfma_f32_32x32x16_bf16 v[160:175], v[56:59], v[88:91], v[160:175]
    ds_read_b64_tr_b16 a[50:51], v12 offset:38912
    v_exp_f32 v16, v16
    v_add_f32 v3, v3, v47
    v_cvt_pk_bf16_f32 v95, v46, v47
    v_mfma_f32_32x32x16_bf16 v[176:191], v[60:63], v[88:91], v[176:191]
    ds_read_b64_tr_b16 a[52:53], v13 offset:36864
    ds_read_b64_tr_b16 a[54:55], v13 offset:38912
    v_exp_f32 v17, v17
    v_add_f32 v3, v3, v16
    v_mfma_f32_32x32x16_bf16 v[128:143], v[64:67], v[92:95], v[128:143]
    ds_read_b64_tr_b16 a[56:57], v14 offset:36864
    v_exp_f32 v18, v18
    v_add_f32 v3, v3, v17
    v_cvt_pk_bf16_f32 v80, v16, v17
    v_mfma_f32_32x32x16_bf16 v[144:159], v[68:71], v[92:95], v[144:159]
    ds_read_b64_tr_b16 a[58:59], v14 offset:38912
    ds_read_b64_tr_b16 a[60:61], v15 offset:36864
    v_exp_f32 v19, v19
    v_add_f32 v3, v3, v18
    v_mfma_f32_32x32x16_bf16 v[160:175], v[72:75], v[92:95], v[160:175]
    ds_read_b64_tr_b16 a[62:63], v15 offset:38912
    v_exp_f32 v20, v20
    v_add_f32 v3, v3, v19
    v_cvt_pk_bf16_f32 v81, v18, v19
    v_mfma_f32_32x32x16_bf16 v[176:191], v[76:79], v[92:95], v[176:191]
    v_exp_f32 v21, v21
    v_add_f32 v3, v3, v20
    v_add_f32 v3, v3, v21
    v_cvt_pk_bf16_f32 v82, v20, v21
    s_waitcnt lgkmcnt(11)
    v_mfma_f32_32x32x16_bf16 v[32:47], a[0:3], v[96:99], 0
    s_barrier
    ds_read_b128 a[0:3], v4 offset:49152
    v_mfma_f32_32x32x16_bf16 v[32:47], a[4:7], v[100:103], v[32:47]
    ds_read_b128 a[4:7], v5 offset:49152
    ds_read_b64_tr_b16 v[48:49], v12 offset:40960
    v_exp_f32 v22, v22
    v_exp_f32 v23, v23
    v_mfma_f32_32x32x16_bf16 v[32:47], a[8:11], v[104:107], v[32:47]
    ds_read_b128 a[8:11], v6 offset:49152
    v_exp_f32 v24, v24
    v_add_f32 v3, v3, v22
    v_add_f32 v3, v3, v23
    v_cvt_pk_bf16_f32 v83, v22, v23
    v_mfma_f32_32x32x16_bf16 v[32:47], a[12:15], v[108:111], v[32:47]
    ds_read_b128 a[12:15], v7 offset:49152
    ds_read_b64_tr_b16 v[50:51], v12 offset:43008
    v_exp_f32 v25, v25
    v_add_f32 v3, v3, v24
    v_mfma_f32_32x32x16_bf16 v[32:47], a[16:19], v[112:115], v[32:47]
    ds_read_b128 a[16:19], v8 offset:49152
    ds_read_b64_tr_b16 v[52:53], v13 offset:40960
    v_exp_f32 v26, v26
    v_add_f32 v3, v3, v25
    v_cvt_pk_bf16_f32 v84, v24, v25
    v_mfma_f32_32x32x16_bf16 v[32:47], a[20:23], v[116:119], v[32:47]
    ds_read_b128 a[20:23], v9 offset:49152
    ds_read_b64_tr_b16 v[54:55], v13 offset:43008
    v_exp_f32 v27, v27
    v_add_f32 v3, v3, v26
    v_mfma_f32_32x32x16_bf16 v[32:47], a[24:27], v[120:123], v[32:47]
    ds_read_b128 a[24:27], v10 offset:49152
    ds_read_b64_tr_b16 v[56:57], v14 offset:40960
    v_exp_f32 v28, v28
    v_add_f32 v3, v3, v27
    v_cvt_pk_bf16_f32 v85, v26, v27
    v_mfma_f32_32x32x16_bf16 v[32:47], a[28:31], v[124:127], v[32:47]
    ds_read_b128 a[28:31], v11 offset:49152
    ds_read_b64_tr_b16 v[58:59], v14 offset:43008
    v_exp_f32 v29, v29
    v_add_f32 v3, v3, v28
    s_waitcnt lgkmcnt(14)
    v_mfma_f32_32x32x16_bf16 v[128:143], a[32:35], v[80:83], v[128:143]
    ds_read_b64_tr_b16 v[60:61], v15 offset:40960
    v_exp_f32 v30, v30
    v_add_f32 v3, v3, v29
    v_cvt_pk_bf16_f32 v86, v28, v29
    v_mfma_f32_32x32x16_bf16 v[144:159], a[36:39], v[80:83], v[144:159]
    ds_read_b64_tr_b16 v[62:63], v15 offset:43008
    ds_read_b64_tr_b16 v[64:65], v12 offset:45056
    v_exp_f32 v31, v31
    v_add_f32 v3, v3, v30
    v_mfma_f32_32x32x16_bf16 v[160:175], a[40:43], v[80:83], v[160:175]
    ds_read_b64_tr_b16 v[66:67], v12 offset:47104
    v_exp_f32 v32, v32
    v_add_f32 v3, v3, v31
    v_cvt_pk_bf16_f32 v87, v30, v31
    v_mfma_f32_32x32x16_bf16 v[176:191], a[44:47], v[80:83], v[176:191]
    ds_read_b64_tr_b16 v[68:69], v13 offset:45056
    ds_read_b64_tr_b16 v[70:71], v13 offset:47104
    v_exp_f32 v33, v33
    v_add_f32 v3, v3, v32
    v_mfma_f32_32x32x16_bf16 v[128:143], a[48:51], v[84:87], v[128:143]
    ds_read_b64_tr_b16 v[72:73], v14 offset:45056
    v_exp_f32 v34, v34
    v_add_f32 v3, v3, v33
    v_cvt_pk_bf16_f32 v88, v32, v33
    v_mfma_f32_32x32x16_bf16 v[144:159], a[52:55], v[84:87], v[144:159]
    ds_read_b64_tr_b16 v[74:75], v14 offset:47104
    ds_read_b64_tr_b16 v[76:77], v15 offset:45056
    v_exp_f32 v35, v35
    v_add_f32 v3, v3, v34
    v_mfma_f32_32x32x16_bf16 v[160:175], a[56:59], v[84:87], v[160:175]
    ds_read_b64_tr_b16 v[78:79], v15 offset:47104
    v_exp_f32 v36, v36
    v_add_f32 v3, v3, v35
    v_cvt_pk_bf16_f32 v89, v34, v35
    v_mfma_f32_32x32x16_bf16 v[176:191], a[60:63], v[84:87], v[176:191]
    v_exp_f32 v37, v37
    v_add_f32 v3, v3, v36
    v_add_f32 v3, v3, v37
    v_cvt_pk_bf16_f32 v90, v36, v37
    s_waitcnt lgkmcnt(11)
    v_mfma_f32_32x32x16_bf16 v[16:31], a[0:3], v[96:99], 0
    s_barrier
    ds_read_b128 a[0:3], v4 offset:57344
    v_mfma_f32_32x32x16_bf16 v[16:31], a[4:7], v[100:103], v[16:31]
    ds_read_b128 a[4:7], v5 offset:57344
    ds_read_b64_tr_b16 a[32:33], v12 offset:49152
    v_exp_f32 v38, v38
    v_exp_f32 v39, v39
    v_mfma_f32_32x32x16_bf16 v[16:31], a[8:11], v[104:107], v[16:31]
    ds_read_b128 a[8:11], v6 offset:57344
    v_exp_f32 v40, v40
    v_add_f32 v3, v3, v38
    v_add_f32 v3, v3, v39
    v_cvt_pk_bf16_f32 v91, v38, v39
    v_mfma_f32_32x32x16_bf16 v[16:31], a[12:15], v[108:111], v[16:31]
    ds_read_b128 a[12:15], v7 offset:57344
    ds_read_b64_tr_b16 a[34:35], v12 offset:51200
    v_exp_f32 v41, v41
    v_add_f32 v3, v3, v40
    v_mfma_f32_32x32x16_bf16 v[16:31], a[16:19], v[112:115], v[16:31]
    ds_read_b128 a[16:19], v8 offset:57344
    ds_read_b64_tr_b16 a[36:37], v13 offset:49152
    v_exp_f32 v42, v42
    v_add_f32 v3, v3, v41
    v_cvt_pk_bf16_f32 v92, v40, v41
    v_mfma_f32_32x32x16_bf16 v[16:31], a[20:23], v[116:119], v[16:31]
    ds_read_b128 a[20:23], v9 offset:57344
    ds_read_b64_tr_b16 a[38:39], v13 offset:51200
    v_exp_f32 v43, v43
    v_add_f32 v3, v3, v42
    v_mfma_f32_32x32x16_bf16 v[16:31], a[24:27], v[120:123], v[16:31]
    ds_read_b128 a[24:27], v10 offset:57344
    ds_read_b64_tr_b16 a[40:41], v14 offset:49152
    v_exp_f32 v44, v44
    v_add_f32 v3, v3, v43
    v_cvt_pk_bf16_f32 v93, v42, v43
    v_mfma_f32_32x32x16_bf16 v[16:31], a[28:31], v[124:127], v[16:31]
    ds_read_b128 a[28:31], v11 offset:57344
    ds_read_b64_tr_b16 a[42:43], v14 offset:51200
    v_exp_f32 v45, v45
    v_add_f32 v3, v3, v44
    s_waitcnt lgkmcnt(14)
    v_mfma_f32_32x32x16_bf16 v[128:143], v[48:51], v[88:91], v[128:143]
    ds_read_b64_tr_b16 a[44:45], v15 offset:49152
    v_exp_f32 v46, v46
    v_add_f32 v3, v3, v45
    v_cvt_pk_bf16_f32 v94, v44, v45
    v_mfma_f32_32x32x16_bf16 v[144:159], v[52:55], v[88:91], v[144:159]
    ds_read_b64_tr_b16 a[46:47], v15 offset:51200
    ds_read_b64_tr_b16 a[48:49], v12 offset:53248
    v_exp_f32 v47, v47
    v_add_f32 v3, v3, v46
    v_mfma_f32_32x32x16_bf16 v[160:175], v[56:59], v[88:91], v[160:175]
    ds_read_b64_tr_b16 a[50:51], v12 offset:55296
    v_exp_f32 v16, v16
    v_add_f32 v3, v3, v47
    v_cvt_pk_bf16_f32 v95, v46, v47
    v_mfma_f32_32x32x16_bf16 v[176:191], v[60:63], v[88:91], v[176:191]
    ds_read_b64_tr_b16 a[52:53], v13 offset:53248
    ds_read_b64_tr_b16 a[54:55], v13 offset:55296
    v_exp_f32 v17, v17
    v_add_f32 v3, v3, v16
    v_mfma_f32_32x32x16_bf16 v[128:143], v[64:67], v[92:95], v[128:143]
    ds_read_b64_tr_b16 a[56:57], v14 offset:53248
    v_exp_f32 v18, v18
    v_add_f32 v3, v3, v17
    v_cvt_pk_bf16_f32 v80, v16, v17
    v_mfma_f32_32x32x16_bf16 v[144:159], v[68:71], v[92:95], v[144:159]
    ds_read_b64_tr_b16 a[58:59], v14 offset:55296
    ds_read_b64_tr_b16 a[60:61], v15 offset:53248
    v_exp_f32 v19, v19
    v_add_f32 v3, v3, v18
    v_mfma_f32_32x32x16_bf16 v[160:175], v[72:75], v[92:95], v[160:175]
    ds_read_b64_tr_b16 a[62:63], v15 offset:55296
    v_exp_f32 v20, v20
    v_add_f32 v3, v3, v19
    v_cvt_pk_bf16_f32 v81, v18, v19
    v_mfma_f32_32x32x16_bf16 v[176:191], v[76:79], v[92:95], v[176:191]
    v_exp_f32 v21, v21
    v_add_f32 v3, v3, v20
    v_add_f32 v3, v3, v21
    v_cvt_pk_bf16_f32 v82, v20, v21
    s_waitcnt lgkmcnt(11)
    v_mfma_f32_32x32x16_bf16 v[32:47], a[0:3], v[96:99], 0
    s_barrier
    ds_read_b128 a[0:3], v4 offset:0
    v_mfma_f32_32x32x16_bf16 v[32:47], a[4:7], v[100:103], v[32:47]
    ds_read_b128 a[4:7], v5 offset:0
    ds_read_b64_tr_b16 v[48:49], v12 offset:57344
    v_exp_f32 v22, v22
    v_exp_f32 v23, v23
    v_mfma_f32_32x32x16_bf16 v[32:47], a[8:11], v[104:107], v[32:47]
    ds_read_b128 a[8:11], v6 offset:0
    v_exp_f32 v24, v24
    v_add_f32 v3, v3, v22
    v_add_f32 v3, v3, v23
    v_cvt_pk_bf16_f32 v83, v22, v23
    v_mfma_f32_32x32x16_bf16 v[32:47], a[12:15], v[108:111], v[32:47]
    ds_read_b128 a[12:15], v7 offset:0
    ds_read_b64_tr_b16 v[50:51], v12 offset:59392
    v_exp_f32 v25, v25
    v_add_f32 v3, v3, v24
    v_mfma_f32_32x32x16_bf16 v[32:47], a[16:19], v[112:115], v[32:47]
    ds_read_b128 a[16:19], v8 offset:0
    ds_read_b64_tr_b16 v[52:53], v13 offset:57344
    v_exp_f32 v26, v26
    v_add_f32 v3, v3, v25
    v_cvt_pk_bf16_f32 v84, v24, v25
    v_mfma_f32_32x32x16_bf16 v[32:47], a[20:23], v[116:119], v[32:47]
    ds_read_b128 a[20:23], v9 offset:0
    ds_read_b64_tr_b16 v[54:55], v13 offset:59392
    v_exp_f32 v27, v27
    v_add_f32 v3, v3, v26
    v_mfma_f32_32x32x16_bf16 v[32:47], a[24:27], v[120:123], v[32:47]
    ds_read_b128 a[24:27], v10 offset:0
    ds_read_b64_tr_b16 v[56:57], v14 offset:57344
    v_exp_f32 v28, v28
    v_add_f32 v3, v3, v27
    v_cvt_pk_bf16_f32 v85, v26, v27
    v_mfma_f32_32x32x16_bf16 v[32:47], a[28:31], v[124:127], v[32:47]
    ds_read_b128 a[28:31], v11 offset:0
    ds_read_b64_tr_b16 v[58:59], v14 offset:59392
    v_exp_f32 v29, v29
    v_add_f32 v3, v3, v28
    s_waitcnt lgkmcnt(14)
    v_mfma_f32_32x32x16_bf16 v[128:143], a[32:35], v[80:83], v[128:143]
    ds_read_b64_tr_b16 v[60:61], v15 offset:57344
    v_exp_f32 v30, v30
    v_add_f32 v3, v3, v29
    v_cvt_pk_bf16_f32 v86, v28, v29
    v_mfma_f32_32x32x16_bf16 v[144:159], a[36:39], v[80:83], v[144:159]
    ds_read_b64_tr_b16 v[62:63], v15 offset:59392
    ds_read_b64_tr_b16 v[64:65], v12 offset:61440
    v_exp_f32 v31, v31
    v_add_f32 v3, v3, v30
    v_mfma_f32_32x32x16_bf16 v[160:175], a[40:43], v[80:83], v[160:175]
    ds_read_b64_tr_b16 v[66:67], v12 offset:63488
    v_exp_f32 v32, v32
    v_add_f32 v3, v3, v31
    v_cvt_pk_bf16_f32 v87, v30, v31
    v_mfma_f32_32x32x16_bf16 v[176:191], a[44:47], v[80:83], v[176:191]
    ds_read_b64_tr_b16 v[68:69], v13 offset:61440
    ds_read_b64_tr_b16 v[70:71], v13 offset:63488
    v_exp_f32 v33, v33
    v_add_f32 v3, v3, v32
    v_mfma_f32_32x32x16_bf16 v[128:143], a[48:51], v[84:87], v[128:143]
    ds_read_b64_tr_b16 v[72:73], v14 offset:61440
    v_exp_f32 v34, v34
    v_add_f32 v3, v3, v33
    v_cvt_pk_bf16_f32 v88, v32, v33
    v_mfma_f32_32x32x16_bf16 v[144:159], a[52:55], v[84:87], v[144:159]
    ds_read_b64_tr_b16 v[74:75], v14 offset:63488
    ds_read_b64_tr_b16 v[76:77], v15 offset:61440
    v_exp_f32 v35, v35
    v_add_f32 v3, v3, v34
    v_mfma_f32_32x32x16_bf16 v[160:175], a[56:59], v[84:87], v[160:175]
    ds_read_b64_tr_b16 v[78:79], v15 offset:63488
    v_exp_f32 v36, v36
    v_add_f32 v3, v3, v35
    v_cvt_pk_bf16_f32 v89, v34, v35
    v_mfma_f32_32x32x16_bf16 v[176:191], a[60:63], v[84:87], v[176:191]
    v_exp_f32 v37, v37
    v_add_f32 v3, v3, v36
    v_add_f32 v3, v3, v37
    v_cvt_pk_bf16_f32 v90, v36, v37
    s_cmp_eq_u32 s30, 3
    s_cbranch_scc1 L_drain
    s_waitcnt lgkmcnt(11)
    v_mfma_f32_32x32x16_bf16 v[16:31], a[0:3], v[96:99], 0
    s_barrier
    ds_read_b128 a[0:3], v4 offset:8192
    v_mfma_f32_32x32x16_bf16 v[16:31], a[4:7], v[100:103], v[16:31]
    ds_read_b128 a[4:7], v5 offset:8192
    ds_read_b64_tr_b16 a[32:33], v12 offset:0
    v_exp_f32 v38, v38
    v_exp_f32 v39, v39
    v_mfma_f32_32x32x16_bf16 v[16:31], a[8:11], v[104:107], v[16:31]
    ds_read_b128 a[8:11], v6 offset:8192
    v_exp_f32 v40, v40
    v_add_f32 v3, v3, v38
    v_add_f32 v3, v3, v39
    v_cvt_pk_bf16_f32 v91, v38, v39
    v_mfma_f32_32x32x16_bf16 v[16:31], a[12:15], v[108:111], v[16:31]
    ds_read_b128 a[12:15], v7 offset:8192
    ds_read_b64_tr_b16 a[34:35], v12 offset:2048
    v_exp_f32 v41, v41
    v_add_f32 v3, v3, v40
    v_mfma_f32_32x32x16_bf16 v[16:31], a[16:19], v[112:115], v[16:31]
    ds_read_b128 a[16:19], v8 offset:8192
    ds_read_b64_tr_b16 a[36:37], v13 offset:0
    v_exp_f32 v42, v42
    v_add_f32 v3, v3, v41
    v_cvt_pk_bf16_f32 v92, v40, v41
    v_mfma_f32_32x32x16_bf16 v[16:31], a[20:23], v[116:119], v[16:31]
    ds_read_b128 a[20:23], v9 offset:8192
    ds_read_b64_tr_b16 a[38:39], v13 offset:2048
    v_exp_f32 v43, v43
    v_add_f32 v3, v3, v42
    v_mfma_f32_32x32x16_bf16 v[16:31], a[24:27], v[120:123], v[16:31]
    ds_read_b128 a[24:27], v10 offset:8192
    ds_read_b64_tr_b16 a[40:41], v14 offset:0
    v_exp_f32 v44, v44
    v_add_f32 v3, v3, v43
    v_cvt_pk_bf16_f32 v93, v42, v43
    v_mfma_f32_32x32x16_bf16 v[16:31], a[28:31], v[124:127], v[16:31]
    ds_read_b128 a[28:31], v11 offset:8192
    ds_read_b64_tr_b16 a[42:43], v14 offset:2048
    v_exp_f32 v45, v45
    v_add_f32 v3, v3, v44
    s_waitcnt lgkmcnt(14)
    v_mfma_f32_32x32x16_bf16 v[128:143], v[48:51], v[88:91], v[128:143]
    ds_read_b64_tr_b16 a[44:45], v15 offset:0
    v_exp_f32 v46, v46
    v_add_f32 v3, v3, v45
    v_cvt_pk_bf16_f32 v94, v44, v45
    v_mfma_f32_32x32x16_bf16 v[144:159], v[52:55], v[88:91], v[144:159]
    ds_read_b64_tr_b16 a[46:47], v15 offset:2048
    ds_read_b64_tr_b16 a[48:49], v12 offset:4096
    v_exp_f32 v47, v47
    v_add_f32 v3, v3, v46
    v_mfma_f32_32x32x16_bf16 v[160:175], v[56:59], v[88:91], v[160:175]
    ds_read_b64_tr_b16 a[50:51], v12 offset:6144
    v_exp_f32 v16, v16
    v_add_f32 v3, v3, v47
    v_cvt_pk_bf16_f32 v95, v46, v47
    v_mfma_f32_32x32x16_bf16 v[176:191], v[60:63], v[88:91], v[176:191]
    ds_read_b64_tr_b16 a[52:53], v13 offset:4096
    ds_read_b64_tr_b16 a[54:55], v13 offset:6144
    v_exp_f32 v17, v17
    v_add_f32 v3, v3, v16
    v_mfma_f32_32x32x16_bf16 v[128:143], v[64:67], v[92:95], v[128:143]
    ds_read_b64_tr_b16 a[56:57], v14 offset:4096
    v_exp_f32 v18, v18
    v_add_f32 v3, v3, v17
    v_cvt_pk_bf16_f32 v80, v16, v17
    v_mfma_f32_32x32x16_bf16 v[144:159], v[68:71], v[92:95], v[144:159]
    ds_read_b64_tr_b16 a[58:59], v14 offset:6144
    ds_read_b64_tr_b16 a[60:61], v15 offset:4096
    v_exp_f32 v19, v19
    v_add_f32 v3, v3, v18
    v_mfma_f32_32x32x16_bf16 v[160:175], v[72:75], v[92:95], v[160:175]
    ds_read_b64_tr_b16 a[62:63], v15 offset:6144
    v_exp_f32 v20, v20
    v_add_f32 v3, v3, v19
    v_cvt_pk_bf16_f32 v81, v18, v19
    v_mfma_f32_32x32x16_bf16 v[176:191], v[76:79], v[92:95], v[176:191]
    v_exp_f32 v21, v21
    v_add_f32 v3, v3, v20
    v_add_f32 v3, v3, v21
    v_cvt_pk_bf16_f32 v82, v20, v21
    s_add_u32 s30, s30, 1
    s_branch L_p2loop
L_drain:
    v_mov_b32 v18, 0
    buffer_load_dwordx2 v[16:17], v18, s[52:55], 0 offen offset:128 sc1
    v_exp_f32 v38, v38
    v_exp_f32 v39, v39
    v_exp_f32 v40, v40
    v_add_f32 v3, v3, v38
    v_add_f32 v3, v3, v39
    v_cvt_pk_bf16_f32 v91, v38, v39
    s_waitcnt lgkmcnt(0)
    v_exp_f32 v41, v41
    v_mfma_f32_32x32x16_bf16 v[128:143], v[48:51], v[88:91], v[128:143]
    v_add_f32 v3, v3, v40
    v_exp_f32 v42, v42
    v_add_f32 v3, v3, v41
    v_cvt_pk_bf16_f32 v92, v40, v41
    v_mfma_f32_32x32x16_bf16 v[144:159], v[52:55], v[88:91], v[144:159]
    v_exp_f32 v43, v43
    v_add_f32 v3, v3, v42
    v_exp_f32 v44, v44
    v_mfma_f32_32x32x16_bf16 v[160:175], v[56:59], v[88:91], v[160:175]
    v_add_f32 v3, v3, v43
    v_cvt_pk_bf16_f32 v93, v42, v43
    v_exp_f32 v45, v45
    v_add_f32 v3, v3, v44
    v_mfma_f32_32x32x16_bf16 v[176:191], v[60:63], v[88:91], v[176:191]
    v_exp_f32 v46, v46
    v_add_f32 v3, v3, v45
    v_cvt_pk_bf16_f32 v94, v44, v45
    v_exp_f32 v47, v47
    v_add_f32 v3, v3, v46
    s_nop 0
    v_add_f32 v3, v3, v47
    v_cvt_pk_bf16_f32 v95, v46, v47
    s_nop 1
    v_mfma_f32_32x32x16_bf16 v[128:143], v[64:67], v[92:95], v[128:143]
    v_mfma_f32_32x32x16_bf16 v[144:159], v[68:71], v[92:95], v[144:159]
    v_mfma_f32_32x32x16_bf16 v[160:175], v[72:75], v[92:95], v[160:175]
    v_mfma_f32_32x32x16_bf16 v[176:191], v[76:79], v[92:95], v[176:191]
    v_mov_b32 v48, v3
    v_mov_b32 v49, v48
    s_nop 1
    v_permlane32_swap_b32 v48, v49
    s_nop 1
    v_add_f32 v48, v48, v49
    s_mov_b32 s38, 0
    v_cmp_le_f32 vcc, s32, v48
    v_cmp_ge_f32 s[34:35], s33, v48
    v_rcp_f32 v50, v48
    s_nop 1
    s_and_b64 s[34:35], s[34:35], vcc
    s_andn2_b64 s[34:35], s[36:37], s[34:35]
    s_cbranch_scc1 L_fallback
L_epi:
    v_mov_b32 v51, v50
    s_mov_b64 exec, s[36:37]
    v_pk_mul_f32 v[128:129], v[128:129], v[50:51]
    v_pk_mul_f32 v[130:131], v[130:131], v[50:51]
    v_pk_mul_f32 v[132:133], v[132:133], v[50:51]
    v_pk_mul_f32 v[134:135], v[134:135], v[50:51]
    v_cvt_pk_bf16_f32 v56, v128, v129
    v_cvt_pk_bf16_f32 v57, v130, v131
    v_cvt_pk_bf16_f32 v58, v132, v133
    v_cvt_pk_bf16_f32 v59, v134, v135
    buffer_store_dwordx4 v[56:59], v2, s[40:43], s39 offen offset:0 sc1
    v_pk_mul_f32 v[136:137], v[136:137], v[50:51]
    v_pk_mul_f32 v[138:139], v[138:139], v[50:51]
    v_pk_mul_f32 v[140:141], v[140:141], v[50:51]
    v_pk_mul_f32 v[142:143], v[142:143], v[50:51]
    v_cvt_pk_bf16_f32 v60, v136, v137
    v_cvt_pk_bf16_f32 v61, v138, v139
    v_cvt_pk_bf16_f32 v62, v140, v141
    v_cvt_pk_bf16_f32 v63, v142, v143
    buffer_store_dwordx4 v[60:63], v2, s[40:43], s39 offen offset:512 sc1
    v_pk_mul_f32 v[144:145], v[144:145], v[50:51]
    v_pk_mul_f32 v[146:147], v[146:147], v[50:51]
    v_pk_mul_f32 v[148:149], v[148:149], v[50:51]
    v_pk_mul_f32 v[150:151], v[150:151], v[50:51]
    v_cvt_pk_bf16_f32 v64, v144, v145
    v_cvt_pk_bf16_f32 v65, v146, v147
    v_cvt_pk_bf16_f32 v66, v148, v149
    v_cvt_pk_bf16_f32 v67, v150, v151
    buffer_store_dwordx4 v[64:67], v2, s[40:43], s39 offen offset:1024 sc1
    v_pk_mul_f32 v[152:153], v[152:153], v[50:51]
    v_pk_mul_f32 v[154:155], v[154:155], v[50:51]
    v_pk_mul_f32 v[156:157], v[156:157], v[50:51]
    v_pk_mul_f32 v[158:159], v[158:159], v[50:51]
    v_cvt_pk_bf16_f32 v68, v152, v153
    v_cvt_pk_bf16_f32 v69, v154, v155
    v_cvt_pk_bf16_f32 v70, v156, v157
    v_cvt_pk_bf16_f32 v71, v158, v159
    buffer_store_dwordx4 v[68:71], v2, s[40:43], s39 offen offset:1536 sc1
    v_pk_mul_f32 v[160:161], v[160:161], v[50:51]
    v_pk_mul_f32 v[162:163], v[162:163], v[50:51]
    v_pk_mul_f32 v[164:165], v[164:165], v[50:51]
    v_pk_mul_f32 v[166:167], v[166:167], v[50:51]
    v_cvt_pk_bf16_f32 v56, v160, v161
    v_cvt_pk_bf16_f32 v57, v162, v163
    v_cvt_pk_bf16_f32 v58, v164, v165
    v_cvt_pk_bf16_f32 v59, v166, v167
    buffer_store_dwordx4 v[56:59], v2, s[40:43], s39 offen offset:2048 sc1
    v_pk_mul_f32 v[168:169], v[168:169], v[50:51]
    v_pk_mul_f32 v[170:171], v[170:171], v[50:51]
    v_pk_mul_f32 v[172:173], v[172:173], v[50:51]
    v_pk_mul_f32 v[174:175], v[174:175], v[50:51]
    v_cvt_pk_bf16_f32 v60, v168, v169
    v_cvt_pk_bf16_f32 v61, v170, v171
    v_cvt_pk_bf16_f32 v62, v172, v173
    v_cvt_pk_bf16_f32 v63, v174, v175
    buffer_store_dwordx4 v[60:63], v2, s[40:43], s39 offen offset:2560 sc1
    v_pk_mul_f32 v[176:177], v[176:177], v[50:51]
    v_pk_mul_f32 v[178:179], v[178:179], v[50:51]
    v_pk_mul_f32 v[180:181], v[180:181], v[50:51]
    v_pk_mul_f32 v[182:183], v[182:183], v[50:51]
    v_cvt_pk_bf16_f32 v64, v176, v177
    v_cvt_pk_bf16_f32 v65, v178, v179
    v_cvt_pk_bf16_f32 v66, v180, v181
    v_cvt_pk_bf16_f32 v67, v182, v183
    buffer_store_dwordx4 v[64:67], v2, s[40:43], s39 offen offset:3072 sc1
    v_pk_mul_f32 v[184:185], v[184:185], v[50:51]
    v_pk_mul_f32 v[186:187], v[186:187], v[50:51]
    v_pk_mul_f32 v[188:189], v[188:189], v[50:51]
    v_pk_mul_f32 v[190:191], v[190:191], v[50:51]
    v_cvt_pk_bf16_f32 v68, v184, v185
    v_cvt_pk_bf16_f32 v69, v186, v187
    v_cvt_pk_bf16_f32 v70, v188, v189
    v_cvt_pk_bf16_f32 v71, v190, v191
    buffer_store_dwordx4 v[68:71], v2, s[40:43], s39 offen offset:3584 sc1
    s_mov_b64 exec, -1
    s_cmp_lg_u32 s38, 0
    s_cbranch_scc1 L_nob3b
    s_barrier
L_nob3b:
    s_waitcnt vmcnt(8)
    v_readfirstlane_b32 s60, v16
    v_readfirstlane_b32 s61, v17
    s_and_b32 s28, s2, 7
    s_lshr_b32 s29, s2, 3
    s_and_b32 s30, s28, 3
    s_lshr_b32 s28, s28, 2
    s_lshl_b32 s28, s28, 5
    s_add_u32 s29, s29, s28
    s_mul_hi_u32 s59, s29, 613566757
    s_mul_i32 s28, s59, 7
    s_sub_u32 s28, s29, s28
    s_mul_i32 s58, s30, 7
    s_add_u32 s58, s58, s28
    s_mov_b32 s57, 0
    v_lshrrev_b32 v5, 3, v0
    s_mov_b32 s24, 1152
    v_mul_lo_u32 v5, v5, s24
    v_bfe_u32 v10, v0, 4, 1
    v_lshlrev_b32 v10, 2, v10
    v_and_b32 v11, 7, v0
    v_xor_b32 v10, v10, v11
    v_lshlrev_b32 v10, 4, v10
    v_add_u32 v5, v5, v10
    s_lshl_b32 s28, s58, 9
    s_lshl_b32 s29, s23, 6
    s_add_u32 s28, s28, s29
    s_lshl_b32 s28, s28, 9
    s_mul_i32 s29, s23, 1179648
    s_lshl_b32 s24, s59, 7
    s_add_u32 s29, s29, s24
    s_mov_b32 s31, s29
    s_add_u32 s29, s29, 294912
    s_lshl_b32 s30, s23, 15
    s_mov_b32 s44, s12
    s_mov_b32 s45, s13
    s_mov_b32 s46, 4718592
    s_mov_b32 s47, 0x20000
    s_mov_b32 s48, s14
    s_mov_b32 s49, s15
    s_mov_b32 s50, 1032192
    s_mov_b32 s51, 0x20000
    v_lshrrev_b32 v3, 5, v0
    v_and_b32 v6, 15, v0
    v_lshrrev_b32 v6, 2, v6
    v_lshlrev_b32 v7, 2, v3
    v_add_u32 v7, v7, v6
    v_lshlrev_b32 v7, 7, v7
    v_bfe_u32 v10, v0, 4, 1
    v_lshlrev_b32 v10, 5, v10
    v_add_u32 v7, v7, v10
    v_and_b32 v10, 3, v0
    v_lshlrev_b32 v10, 3, v10
    v_add_u32 v7, v7, v10
    v_add_u32 v7, s30, v7
    v_lshrrev_b32 v6, 1, v6
    v_lshlrev_b32 v6, 6, v6
    v_add_u32 v8, v7, v6
    v_xor_b32 v6, 64, v6
    v_add_u32 v9, v7, v6
    v_mov_b32 v16, 0
    v_mov_b32 v17, 0
    v_mov_b32 v18, 0
    v_mov_b32 v19, 0
    v_mov_b32 v20, 0
    v_mov_b32 v21, 0
    v_mov_b32 v22, 0
    v_mov_b32 v23, 0
    v_mov_b32 v24, 0
    v_mov_b32 v25, 0
    v_mov_b32 v26, 0
    v_mov_b32 v27, 0
    v_mov_b32 v28, 0
    v_mov_b32 v29, 0
    v_mov_b32 v30, 0
    v_mov_b32 v31, 0
    v_mov_b32 v32, 0
    v_mov_b32 v33, 0
    v_mov_b32 v34, 0
    v_mov_b32 v35, 0
    v_mov_b32 v36, 0
    v_mov_b32 v37, 0
    v_mov_b32 v38, 0
    v_mov_b32 v39, 0
    v_mov_b32 v40, 0
    v_mov_b32 v41, 0
    v_mov_b32 v42, 0
    v_mov_b32 v43, 0
    v_mov_b32 v44, 0
    v_mov_b32 v45, 0
    v_mov_b32 v46, 0
    v_mov_b32 v47, 0
    s_waitcnt vmcnt(0)
    s_barrier
    s_mov_b32 s56, 0
L_epochc:
    s_add_u32 s56, s56, 1
    s_cmp_lg_u32 s60, 0
    s_cbranch_scc1 L_epoch_okc
    s_cmp_ge_u32 s56, 100000
    s_cbranch_scc1 L_epoch_okc
    v_mov_b32 v14, 0
    buffer_load_dwordx2 v[12:13], v14, s[52:55], 0 offen offset:128 sc1
    s_waitcnt vmcnt(0)
    v_readfirstlane_b32 s60, v12
    v_readfirstlane_b32 s61, v13
    s_nop 3
    s_branch L_epochc
L_epoch_okc:
    s_add_u32 s52, s18, 8388608
    s_addc_u32 s53, s19, 0
    s_mov_b32 s54, 32768
    s_mov_b32 s55, 0x20000
    s_cmp_lg_u32 s23, 0
    s_cbranch_scc1 L_res
    v_mov_b32 v72, s60
    v_mov_b32 v73, s61
    s_lshl_b32 s24, s20, 5
    s_add_u32 s24, s24, s21
    s_lshl_b32 s24, s24, 7
    v_mov_b32 v11, s24
    s_mov_b64 exec, 1
    buffer_store_dwordx2 v[72:73], v11, s[52:55], 0 offen sc1
    s_mov_b64 exec, -1
L_res:
    s_cmp_ge_u32 s2, 252
    s_cbranch_scc1 L_wait_done
    s_mov_b32 s26, s31
    s_mov_b32 s27, s30
    s_mov_b32 s25, 0
    s_cmp_eq_u32 s23, 1
    s_cselect_b32 s25, 4, 16
    s_cmp_lg_u32 s38, 0
    s_cselect_b32 s25, 0, s25
    s_mul_i32 s24, s25, 18432
    s_add_u32 s26, s26, s24
    s_lshl_b32 s24, s25, 11
    s_add_u32 s27, s27, s24
    s_cmp_ge_u32 s25, 16
    s_cbranch_scc1 L_resd
L_resl:
    s_mov_b32 m0, s27
    s_add_u32 s24, s26, 8192
    buffer_load_dwordx4 v5, s[44:47], s26 offen lds
    buffer_load_dwordx4 v5, s[44:47], s24 offen offset:1024 lds
    s_add_u32 s26, s26, 18432
    s_add_u32 s27, s27, 2048
    s_add_u32 s25, s25, 1
    s_cmp_lt_u32 s25, 16
    s_cbranch_scc1 L_resl
L_resd:
    s_lshl_b32 s24, s58, 1
    s_mul_hi_u32 s25, s24, 613566757
    s_add_u32 s24, s24, 1
    s_mul_hi_u32 s24, s24, 613566757
    s_lshl_b32 s24, s24, 12
    s_lshl_b32 s25, s25, 12
    v_and_b32 v11, 7, v0
    v_lshlrev_b32 v11, 7, v11
    s_lshl_b32 s56, s23, 10
    v_add_u32 v11, s56, v11
    v_and_b32 v14, 8, v0
    v_mov_b32 v12, s25
    v_mov_b32 v13, s24
    v_cmp_eq_u32 vcc, 0, v14
    s_nop 1
    v_cndmask_b32 v12, v13, v12, vcc
    v_add_u32 v11, v11, v12
    s_mov_b32 s56, 0
    s_mov_b64 exec, 0x3f3f
L_pollc:
    buffer_load_dwordx2 v[12:13], v11, s[52:55], 0 offen sc1
    s_waitcnt vmcnt(0)
    v_cmp_eq_u32 vcc, s60, v12
    v_cmp_eq_u32 s[62:63], s61, v13
    s_nop 1
    s_and_b64 s[62:63], s[62:63], vcc
    s_add_u32 s56, s56, 1
    s_cmp_eq_u64 s[62:63], 0x3f3f
    s_cbranch_scc1 L_polldc
    s_cmp_ge_u32 s56, 100000
    s_cbranch_scc1 L_polldc
    s_sleep 1
    s_branch L_pollc
L_polldc:
    s_mov_b64 exec, -1
L_wait_done:
    s_cmp_ge_u32 s2, 252
    s_cbranch_scc1 L_fin
    buffer_load_dwordx4 v[64:67], v2, s[40:43], s28 offen sc1
    s_add_u32 s28, s28, 512
    buffer_load_dwordx4 v[68:71], v2, s[40:43], s28 offen sc1
    s_add_u32 s28, s28, 512
    buffer_load_dwordx4 v[72:75], v2, s[40:43], s28 offen sc1
    s_add_u32 s28, s28, 512
    buffer_load_dwordx4 v[76:79], v2, s[40:43], s28 offen sc1
    s_add_u32 s28, s28, 512
    buffer_load_dwordx4 v[80:83], v2, s[40:43], s28 offen sc1
    s_add_u32 s28, s28, 512
    buffer_load_dwordx4 v[84:87], v2, s[40:43], s28 offen sc1
    s_add_u32 s28, s28, 512
    buffer_load_dwordx4 v[88:91], v2, s[40:43], s28 offen sc1
    s_add_u32 s28, s28, 512
    buffer_load_dwordx4 v[92:95], v2, s[40:43], s28 offen sc1
    s_add_u32 s28, s28, 512
    buffer_load_dwordx4 v[96:99], v2, s[40:43], s28 offen sc1
    s_add_u32 s28, s28, 512
    buffer_load_dwordx4 v[100:103], v2, s[40:43], s28 offen sc1
    s_add_u32 s28, s28, 512
    buffer_load_dwordx4 v[104:107], v2, s[40:43], s28 offen sc1
    s_add_u32 s28, s28, 512
    buffer_load_dwordx4 v[108:111], v2, s[40:43], s28 offen sc1
    s_add_u32 s28, s28, 512
    buffer_load_dwordx4 v[112:115], v2, s[40:43], s28 offen sc1
    s_add_u32 s28, s28, 512
    buffer_load_dwordx4 v[116:119], v2, s[40:43], s28 offen sc1
    s_add_u32 s28, s28, 512
    buffer_load_dwordx4 v[120:123], v2, s[40:43], s28 offen sc1
    s_add_u32 s28, s28, 512
    s_waitcnt vmcnt(45)
    ds_read_b64_tr_b16 v[48:49], v8 offset:0
    ds_read_b64_tr_b16 v[50:51], v8 offset:1024
    ds_read_b64_tr_b16 v[52:53], v9 offset:0
    ds_read_b64_tr_b16 v[54:55], v9 offset:1024
    buffer_load_dwordx4 v[124:127], v2, s[40:43], s28 offen sc1
    s_add_u32 s28, s28, 512
    s_waitcnt vmcnt(15)
    ds_read_b64_tr_b16 v[56:57], v8 offset:2048
    ds_read_b64_tr_b16 v[58:59], v8 offset:3072
    ds_read_b64_tr_b16 v[60:61], v9 offset:2048
    ds_read_b64_tr_b16 v[62:63], v9 offset:3072
    s_waitcnt lgkmcnt(4)
    v_mfma_f32_32x32x16_bf16 v[16:31], v[48:51], v[64:67], v[16:31]
    v_mfma_f32_32x32x16_bf16 v[32:47], v[52:55], v[64:67], v[32:47]
    buffer_load_dwordx4 v[128:131], v2, s[40:43], s28 offen sc1
    s_add_u32 s28, s28, 512
    s_add_u32 m0, s30, 0
    s_add_u32 s31, s29, 8192
    buffer_load_dwordx4 v5, s[44:47], s29 offen lds
    buffer_load_dwordx4 v5, s[44:47], s31 offen offset:1024 lds
    s_add_u32 s29, s29, 18432
    s_waitcnt vmcnt(17)
    ds_read_b64_tr_b16 v[48:49], v8 offset:4096
    ds_read_b64_tr_b16 v[50:51], v8 offset:5120
    ds_read_b64_tr_b16 v[52:53], v9 offset:4096
    ds_read_b64_tr_b16 v[54:55], v9 offset:5120
    s_waitcnt lgkmcnt(4)
    v_mfma_f32_32x32x16_bf16 v[16:31], v[56:59], v[68:71], v[16:31]
    v_mfma_f32_32x32x16_bf16 v[32:47], v[60:63], v[68:71], v[32:47]
    buffer_load_dwordx4 v[132:135], v2, s[40:43], s28 offen sc1
    s_add_u32 s28, s28, 512
    s_add_u32 m0, s30, 2048
    s_add_u32 s31, s29, 8192
    buffer_load_dwordx4 v5, s[44:47], s29 offen lds
    buffer_load_dwordx4 v5, s[44:47], s31 offen offset:1024 lds
    s_add_u32 s29, s29, 18432
    s_waitcnt vmcnt(19)
    ds_read_b64_tr_b16 v[56:57], v8 offset:6144
    ds_read_b64_tr_b16 v[58:59], v8 offset:7168
    ds_read_b64_tr_b16 v[60:61], v9 offset:6144
    ds_read_b64_tr_b16 v[62:63], v9 offset:7168
    s_waitcnt lgkmcnt(4)
    v_mfma_f32_32x32x16_bf16 v[16:31], v[48:51], v[72:75], v[16:31]
    v_mfma_f32_32x32x16_bf16 v[32:47], v[52:55], v[72:75], v[32:47]
    buffer_load_dwordx4 v[136:139], v2, s[40:43], s28 offen sc1
    s_add_u32 s28, s28, 512
    s_add_u32 m0, s30, 4096
    s_add_u32 s31, s29, 8192
    buffer_load_dwordx4 v5, s[44:47], s29 offen lds
    buffer_load_dwordx4 v5, s[44:47], s31 offen offset:1024 lds
    s_add_u32 s29, s29, 18432
    s_waitcnt vmcnt(21)
    ds_read_b64_tr_b16 v[48:49], v8 offset:8192
    ds_read_b64_tr_b16 v[50:51], v8 offset:9216
    ds_read_b64_tr_b16 v[52:53], v9 offset:8192
    ds_read_b64_tr_b16 v[54:55], v9 offset:9216
    s_waitcnt lgkmcnt(4)
    v_mfma_f32_32x32x16_bf16 v[16:31], v[56:59], v[76:79], v[16:31]
    v_mfma_f32_32x32x16_bf16 v[32:47], v[60:63], v[76:79], v[32:47]
    buffer_load_dwordx4 v[140:143], v2, s[40:43], s28 offen sc1
    s_add_u32 s28, s28, 512
    s_add_u32 m0, s30, 6144
    s_add_u32 s31, s29, 8192
    buffer_load_dwordx4 v5, s[44:47], s29 offen lds
    buffer_load_dwordx4 v5, s[44:47], s31 offen offset:1024 lds
    s_add_u32 s29, s29, 18432
    s_waitcnt vmcnt(23)
    ds_read_b64_tr_b16 v[56:57], v8 offset:10240
    ds_read_b64_tr_b16 v[58:59], v8 offset:11264
    ds_read_b64_tr_b16 v[60:61], v9 offset:10240
    ds_read_b64_tr_b16 v[62:63], v9 offset:11264
    s_waitcnt lgkmcnt(4)
    v_mfma_f32_32x32x16_bf16 v[16:31], v[48:51], v[80:83], v[16:31]
    v_mfma_f32_32x32x16_bf16 v[32:47], v[52:55], v[80:83], v[32:47]
    buffer_load_dwordx4 v[144:147], v2, s[40:43], s28 offen sc1
    s_add_u32 s28, s28, 512
    s_add_u32 m0, s30, 8192
    s_add_u32 s31, s29, 8192
    buffer_load_dwordx4 v5, s[44:47], s29 offen lds
    buffer_load_dwordx4 v5, s[44:47], s31 offen offset:1024 lds
    s_add_u32 s29, s29, 18432
    s_waitcnt vmcnt(25)
    ds_read_b64_tr_b16 v[48:49], v8 offset:12288
    ds_read_b64_tr_b16 v[50:51], v8 offset:13312
    ds_read_b64_tr_b16 v[52:53], v9 offset:12288
    ds_read_b64_tr_b16 v[54:55], v9 offset:13312
    s_waitcnt lgkmcnt(4)
    v_mfma_f32_32x32x16_bf16 v[16:31], v[56:59], v[84:87], v[16:31]
    v_mfma_f32_32x32x16_bf16 v[32:47], v[60:63], v[84:87], v[32:47]
    buffer_load_dwordx4 v[148:151], v2, s[40:43], s28 offen sc1
    s_add_u32 s28, s28, 512
    s_add_u32 m0, s30, 10240
    s_add_u32 s31, s29, 8192
    buffer_load_dwordx4 v5, s[44:47], s29 offen lds
    buffer_load_dwordx4 v5, s[44:47], s31 offen offset:1024 lds
    s_add_u32 s29, s29, 18432
    s_waitcnt vmcnt(27)
    ds_read_b64_tr_b16 v[56:57], v8 offset:14336
    ds_read_b64_tr_b16 v[58:59], v8 offset:15360
    ds_read_b64_tr_b16 v[60:61], v9 offset:14336
    ds_read_b64_tr_b16 v[62:63], v9 offset:15360
    s_waitcnt lgkmcnt(4)
    v_mfma_f32_32x32x16_bf16 v[16:31], v[48:51], v[88:91], v[16:31]
    v_mfma_f32_32x32x16_bf16 v[32:47], v[52:55], v[88:91], v[32:47]
    buffer_load_dwordx4 v[152:155], v2, s[40:43], s28 offen sc1
    s_add_u32 s28, s28, 512
    s_add_u32 m0, s30, 12288
    s_add_u32 s31, s29, 8192
    buffer_load_dwordx4 v5, s[44:47], s29 offen lds
    buffer_load_dwordx4 v5, s[44:47], s31 offen offset:1024 lds
    s_add_u32 s29, s29, 18432
    s_waitcnt vmcnt(29)
    ds_read_b64_tr_b16 v[48:49], v8 offset:16384
    ds_read_b64_tr_b16 v[50:51], v8 offset:17408
    ds_read_b64_tr_b16 v[52:53], v9 offset:16384
    ds_read_b64_tr_b16 v[54:55], v9 offset:17408
    s_waitcnt lgkmcnt(4)
    v_mfma_f32_32x32x16_bf16 v[16:31], v[56:59], v[92:95], v[16:31]
    v_mfma_f32_32x32x16_bf16 v[32:47], v[60:63], v[92:95], v[32:47]
    buffer_load_dwordx4 v[156:159], v2, s[40:43], s28 offen sc1
    s_add_u32 s28, s28, 512
    s_add_u32 m0, s30, 14336
    s_add_u32 s31, s29, 8192
    buffer_load_dwordx4 v5, s[44:47], s29 offen lds
    buffer_load_dwordx4 v5, s[44:47], s31 offen offset:1024 lds
    s_add_u32 s29, s29, 18432
    s_waitcnt vmcnt(31)
    ds_read_b64_tr_b16 v[56:57], v8 offset:18432
    ds_read_b64_tr_b16 v[58:59], v8 offset:19456
    ds_read_b64_tr_b16 v[60:61], v9 offset:18432
    ds_read_b64_tr_b16 v[62:63], v9 offset:19456
    s_waitcnt lgkmcnt(4)
    v_mfma_f32_32x32x16_bf16 v[16:31], v[48:51], v[96:99], v[16:31]
    v_mfma_f32_32x32x16_bf16 v[32:47], v[52:55], v[96:99], v[32:47]
    buffer_load_dwordx4 v[160:163], v2, s[40:43], s28 offen sc1
    s_add_u32 s28, s28, 512
    s_add_u32 m0, s30, 16384
    s_add_u32 s31, s29, 8192
    buffer_load_dwordx4 v5, s[44:47], s29 offen lds
    buffer_load_dwordx4 v5, s[44:47], s31 offen offset:1024 lds
    s_add_u32 s29, s29, 18432
    s_waitcnt vmcnt(33)
    ds_read_b64_tr_b16 v[48:49], v8 offset:20480
    ds_read_b64_tr_b16 v[50:51], v8 offset:21504
    ds_read_b64_tr_b16 v[52:53], v9 offset:20480
    ds_read_b64_tr_b16 v[54:55], v9 offset:21504
    s_waitcnt lgkmcnt(4)
    v_mfma_f32_32x32x16_bf16 v[16:31], v[56:59], v[100:103], v[16:31]
    v_mfma_f32_32x32x16_bf16 v[32:47], v[60:63], v[100:103], v[32:47]
    buffer_load_dwordx4 v[164:167], v2, s[40:43], s28 offen sc1
    s_add_u32 s28, s28, 512
    s_add_u32 m0, s30, 18432
    s_add_u32 s31, s29, 8192
    buffer_load_dwordx4 v5, s[44:47], s29 offen lds
    buffer_load_dwordx4 v5, s[44:47], s31 offen offset:1024 lds
    s_add_u32 s29, s29, 18432
    s_waitcnt vmcnt(35)
    ds_read_b64_tr_b16 v[56:57], v8 offset:22528
    ds_read_b64_tr_b16 v[58:59], v8 offset:23552
    ds_read_b64_tr_b16 v[60:61], v9 offset:22528
    ds_read_b64_tr_b16 v[62:63], v9 offset:23552
    s_waitcnt lgkmcnt(4)
    v_mfma_f32_32x32x16_bf16 v[16:31], v[48:51], v[104:107], v[16:31]
    v_mfma_f32_32x32x16_bf16 v[32:47], v[52:55], v[104:107], v[32:47]
    buffer_load_dwordx4 v[168:171], v2, s[40:43], s28 offen sc1
    s_add_u32 s28, s28, 512
    s_add_u32 m0, s30, 20480
    s_add_u32 s31, s29, 8192
    buffer_load_dwordx4 v5, s[44:47], s29 offen lds
    buffer_load_dwordx4 v5, s[44:47], s31 offen offset:1024 lds
    s_add_u32 s29, s29, 18432
    s_waitcnt vmcnt(37)
    ds_read_b64_tr_b16 v[48:49], v8 offset:24576
    ds_read_b64_tr_b16 v[50:51], v8 offset:25600
    ds_read_b64_tr_b16 v[52:53], v9 offset:24576
    ds_read_b64_tr_b16 v[54:55], v9 offset:25600
    s_waitcnt lgkmcnt(4)
    v_mfma_f32_32x32x16_bf16 v[16:31], v[56:59], v[108:111], v[16:31]
    v_mfma_f32_32x32x16_bf16 v[32:47], v[60:63], v[108:111], v[32:47]
    buffer_load_dwordx4 v[172:175], v2, s[40:43], s28 offen sc1
    s_add_u32 s28, s28, 512
    s_add_u32 m0, s30, 22528
    s_add_u32 s31, s29, 8192
    buffer_load_dwordx4 v5, s[44:47], s29 offen lds
    buffer_load_dwordx4 v5, s[44:47], s31 offen offset:1024 lds
    s_add_u32 s29, s29, 18432
    s_waitcnt vmcnt(39)
    ds_read_b64_tr_b16 v[56:57], v8 offset:26624
    ds_read_b64_tr_b16 v[58:59], v8 offset:27648
    ds_read_b64_tr_b16 v[60:61], v9 offset:26624
    ds_read_b64_tr_b16 v[62:63], v9 offset:27648
    s_waitcnt lgkmcnt(4)
    v_mfma_f32_32x32x16_bf16 v[16:31], v[48:51], v[112:115], v[16:31]
    v_mfma_f32_32x32x16_bf16 v[32:47], v[52:55], v[112:115], v[32:47]
    buffer_load_dwordx4 v[176:179], v2, s[40:43], s28 offen sc1
    s_add_u32 s28, s28, 512
    s_add_u32 m0, s30, 24576
    s_add_u32 s31, s29, 8192
    buffer_load_dwordx4 v5, s[44:47], s29 offen lds
    buffer_load_dwordx4 v5, s[44:47], s31 offen offset:1024 lds
    s_add_u32 s29, s29, 18432
    s_waitcnt vmcnt(41)
    ds_read_b64_tr_b16 v[48:49], v8 offset:28672
    ds_read_b64_tr_b16 v[50:51], v8 offset:29696
    ds_read_b64_tr_b16 v[52:53], v9 offset:28672
    ds_read_b64_tr_b16 v[54:55], v9 offset:29696
    s_waitcnt lgkmcnt(4)
    v_mfma_f32_32x32x16_bf16 v[16:31], v[56:59], v[116:119], v[16:31]
    v_mfma_f32_32x32x16_bf16 v[32:47], v[60:63], v[116:119], v[32:47]
    buffer_load_dwordx4 v[180:183], v2, s[40:43], s28 offen sc1
    s_add_u32 s28, s28, 512
    s_add_u32 m0, s30, 26624
    s_add_u32 s31, s29, 8192
    buffer_load_dwordx4 v5, s[44:47], s29 offen lds
    buffer_load_dwordx4 v5, s[44:47], s31 offen offset:1024 lds
    s_add_u32 s29, s29, 18432
    s_waitcnt vmcnt(43)
    ds_read_b64_tr_b16 v[56:57], v8 offset:30720
    ds_read_b64_tr_b16 v[58:59], v8 offset:31744
    ds_read_b64_tr_b16 v[60:61], v9 offset:30720
    ds_read_b64_tr_b16 v[62:63], v9 offset:31744
    s_waitcnt lgkmcnt(4)
    v_mfma_f32_32x32x16_bf16 v[16:31], v[48:51], v[120:123], v[16:31]
    v_mfma_f32_32x32x16_bf16 v[32:47], v[52:55], v[120:123], v[32:47]
    buffer_load_dwordx4 v[184:187], v2, s[40:43], s28 offen sc1
    s_add_u32 s28, s28, 512
    s_add_u32 m0, s30, 28672
    s_add_u32 s31, s29, 8192
    buffer_load_dwordx4 v5, s[44:47], s29 offen lds
    buffer_load_dwordx4 v5, s[44:47], s31 offen offset:1024 lds
    s_add_u32 s29, s29, 18432
    s_waitcnt vmcnt(42)
    ds_read_b64_tr_b16 v[48:49], v8 offset:0
    ds_read_b64_tr_b16 v[50:51], v8 offset:1024
    ds_read_b64_tr_b16 v[52:53], v9 offset:0
    ds_read_b64_tr_b16 v[54:55], v9 offset:1024
    s_waitcnt lgkmcnt(4)
    v_mfma_f32_32x32x16_bf16 v[16:31], v[56:59], v[124:127], v[16:31]
    v_mfma_f32_32x32x16_bf16 v[32:47], v[60:63], v[124:127], v[32:47]
    buffer_load_dwordx4 v[188:191], v2, s[40:43], s28 offen sc1
    s_add_u32 s28, s28, 512
    s_add_u32 m0, s30, 30720
    s_add_u32 s31, s29, 8192
    buffer_load_dwordx4 v5, s[44:47], s29 offen lds
    buffer_load_dwordx4 v5, s[44:47], s31 offen offset:1024 lds
    s_add_u32 s29, s29, 18432
    s_waitcnt vmcnt(42)
    ds_read_b64_tr_b16 v[56:57], v8 offset:2048
    ds_read_b64_tr_b16 v[58:59], v8 offset:3072
    ds_read_b64_tr_b16 v[60:61], v9 offset:2048
    ds_read_b64_tr_b16 v[62:63], v9 offset:3072
    s_waitcnt lgkmcnt(4)
    v_mfma_f32_32x32x16_bf16 v[16:31], v[48:51], v[128:131], v[16:31]
    v_mfma_f32_32x32x16_bf16 v[32:47], v[52:55], v[128:131], v[32:47]
    buffer_load_dwordx4 v[64:67], v2, s[40:43], s28 offen sc1
    s_add_u32 s28, s28, 512
    s_add_u32 m0, s30, 0
    s_add_u32 s31, s29, 8192
    buffer_load_dwordx4 v5, s[44:47], s29 offen lds
    buffer_load_dwordx4 v5, s[44:47], s31 offen offset:1024 lds
    s_add_u32 s29, s29, 18432
    s_waitcnt vmcnt(42)
    ds_read_b64_tr_b16 v[48:49], v8 offset:4096
    ds_read_b64_tr_b16 v[50:51], v8 offset:5120
    ds_read_b64_tr_b16 v[52:53], v9 offset:4096
    ds_read_b64_tr_b16 v[54:55], v9 offset:5120
    s_waitcnt lgkmcnt(4)
    v_mfma_f32_32x32x16_bf16 v[16:31], v[56:59], v[132:135], v[16:31]
    v_mfma_f32_32x32x16_bf16 v[32:47], v[60:63], v[132:135], v[32:47]
    buffer_load_dwordx4 v[68:71], v2, s[40:43], s28 offen sc1
    s_add_u32 s28, s28, 512
    s_add_u32 m0, s30, 2048
    s_add_u32 s31, s29, 8192
    buffer_load_dwordx4 v5, s[44:47], s29 offen lds
    buffer_load_dwordx4 v5, s[44:47], s31 offen offset:1024 lds
    s_add_u32 s29, s29, 18432
    s_waitcnt vmcnt(42)
    ds_read_b64_tr_b16 v[56:57], v8 offset:6144
    ds_read_b64_tr_b16 v[58:59], v8 offset:7168
    ds_read_b64_tr_b16 v[60:61], v9 offset:6144
    ds_read_b64_tr_b16 v[62:63], v9 offset:7168
    s_waitcnt lgkmcnt(4)
    v_mfma_f32_32x32x16_bf16 v[16:31], v[48:51], v[136:139], v[16:31]
    v_mfma_f32_32x32x16_bf16 v[32:47], v[52:55], v[136:139], v[32:47]
    buffer_load_dwordx4 v[72:75], v2, s[40:43], s28 offen sc1
    s_add_u32 s28, s28, 512
    s_add_u32 m0, s30, 4096
    s_add_u32 s31, s29, 8192
    buffer_load_dwordx4 v5, s[44:47], s29 offen lds
    buffer_load_dwordx4 v5, s[44:47], s31 offen offset:1024 lds
    s_add_u32 s29, s29, 18432
    s_waitcnt vmcnt(42)
    ds_read_b64_tr_b16 v[48:49], v8 offset:8192
    ds_read_b64_tr_b16 v[50:51], v8 offset:9216
    ds_read_b64_tr_b16 v[52:53], v9 offset:8192
    ds_read_b64_tr_b16 v[54:55], v9 offset:9216
    s_waitcnt lgkmcnt(4)
    v_mfma_f32_32x32x16_bf16 v[16:31], v[56:59], v[140:143], v[16:31]
    v_mfma_f32_32x32x16_bf16 v[32:47], v[60:63], v[140:143], v[32:47]
    buffer_load_dwordx4 v[76:79], v2, s[40:43], s28 offen sc1
    s_add_u32 s28, s28, 512
    s_add_u32 m0, s30, 6144
    s_add_u32 s31, s29, 8192
    buffer_load_dwordx4 v5, s[44:47], s29 offen lds
    buffer_load_dwordx4 v5, s[44:47], s31 offen offset:1024 lds
    s_add_u32 s29, s29, 18432
    s_waitcnt vmcnt(42)
    ds_read_b64_tr_b16 v[56:57], v8 offset:10240
    ds_read_b64_tr_b16 v[58:59], v8 offset:11264
    ds_read_b64_tr_b16 v[60:61], v9 offset:10240
    ds_read_b64_tr_b16 v[62:63], v9 offset:11264
    s_waitcnt lgkmcnt(4)
    v_mfma_f32_32x32x16_bf16 v[16:31], v[48:51], v[144:147], v[16:31]
    v_mfma_f32_32x32x16_bf16 v[32:47], v[52:55], v[144:147], v[32:47]
    buffer_load_dwordx4 v[80:83], v2, s[40:43], s28 offen sc1
    s_add_u32 s28, s28, 512
    s_add_u32 m0, s30, 8192
    s_add_u32 s31, s29, 8192
    buffer_load_dwordx4 v5, s[44:47], s29 offen lds
    buffer_load_dwordx4 v5, s[44:47], s31 offen offset:1024 lds
    s_add_u32 s29, s29, 18432
    s_waitcnt vmcnt(42)
    ds_read_b64_tr_b16 v[48:49], v8 offset:12288
    ds_read_b64_tr_b16 v[50:51], v8 offset:13312
    ds_read_b64_tr_b16 v[52:53], v9 offset:12288
    ds_read_b64_tr_b16 v[54:55], v9 offset:13312
    s_waitcnt lgkmcnt(4)
    v_mfma_f32_32x32x16_bf16 v[16:31], v[56:59], v[148:151], v[16:31]
    v_mfma_f32_32x32x16_bf16 v[32:47], v[60:63], v[148:151], v[32:47]
    buffer_load_dwordx4 v[84:87], v2, s[40:43], s28 offen sc1
    s_add_u32 s28, s28, 512
    s_add_u32 m0, s30, 10240
    s_add_u32 s31, s29, 8192
    buffer_load_dwordx4 v5, s[44:47], s29 offen lds
    buffer_load_dwordx4 v5, s[44:47], s31 offen offset:1024 lds
    s_add_u32 s29, s29, 18432
    s_waitcnt vmcnt(42)
    ds_read_b64_tr_b16 v[56:57], v8 offset:14336
    ds_read_b64_tr_b16 v[58:59], v8 offset:15360
    ds_read_b64_tr_b16 v[60:61], v9 offset:14336
    ds_read_b64_tr_b16 v[62:63], v9 offset:15360
    s_waitcnt lgkmcnt(4)
    v_mfma_f32_32x32x16_bf16 v[16:31], v[48:51], v[152:155], v[16:31]
    v_mfma_f32_32x32x16_bf16 v[32:47], v[52:55], v[152:155], v[32:47]
    buffer_load_dwordx4 v[88:91], v2, s[40:43], s28 offen sc1
    s_add_u32 s28, s28, 512
    s_add_u32 m0, s30, 12288
    s_add_u32 s31, s29, 8192
    buffer_load_dwordx4 v5, s[44:47], s29 offen lds
    buffer_load_dwordx4 v5, s[44:47], s31 offen offset:1024 lds
    s_add_u32 s29, s29, 18432
    s_waitcnt vmcnt(42)
    ds_read_b64_tr_b16 v[48:49], v8 offset:16384
    ds_read_b64_tr_b16 v[50:51], v8 offset:17408
    ds_read_b64_tr_b16 v[52:53], v9 offset:16384
    ds_read_b64_tr_b16 v[54:55], v9 offset:17408
    s_waitcnt lgkmcnt(4)
    v_mfma_f32_32x32x16_bf16 v[16:31], v[56:59], v[156:159], v[16:31]
    v_mfma_f32_32x32x16_bf16 v[32:47], v[60:63], v[156:159], v[32:47]
    buffer_load_dwordx4 v[92:95], v2, s[40:43], s28 offen sc1
    s_add_u32 s28, s28, 512
    s_add_u32 m0, s30, 14336
    s_add_u32 s31, s29, 8192
    buffer_load_dwordx4 v5, s[44:47], s29 offen lds
    buffer_load_dwordx4 v5, s[44:47], s31 offen offset:1024 lds
    s_add_u32 s29, s29, 18432
    s_waitcnt vmcnt(42)
    ds_read_b64_tr_b16 v[56:57], v8 offset:18432
    ds_read_b64_tr_b16 v[58:59], v8 offset:19456
    ds_read_b64_tr_b16 v[60:61], v9 offset:18432
    ds_read_b64_tr_b16 v[62:63], v9 offset:19456
    s_waitcnt lgkmcnt(4)
    v_mfma_f32_32x32x16_bf16 v[16:31], v[48:51], v[160:163], v[16:31]
    v_mfma_f32_32x32x16_bf16 v[32:47], v[52:55], v[160:163], v[32:47]
    buffer_load_dwordx4 v[96:99], v2, s[40:43], s28 offen sc1
    s_add_u32 s28, s28, 512
    s_add_u32 m0, s30, 16384
    s_add_u32 s31, s29, 8192
    buffer_load_dwordx4 v5, s[44:47], s29 offen lds
    buffer_load_dwordx4 v5, s[44:47], s31 offen offset:1024 lds
    s_add_u32 s29, s29, 18432
    s_waitcnt vmcnt(42)
    ds_read_b64_tr_b16 v[48:49], v8 offset:20480
    ds_read_b64_tr_b16 v[50:51], v8 offset:21504
    ds_read_b64_tr_b16 v[52:53], v9 offset:20480
    ds_read_b64_tr_b16 v[54:55], v9 offset:21504
    s_waitcnt lgkmcnt(4)
    v_mfma_f32_32x32x16_bf16 v[16:31], v[56:59], v[164:167], v[16:31]
    v_mfma_f32_32x32x16_bf16 v[32:47], v[60:63], v[164:167], v[32:47]
    buffer_load_dwordx4 v[100:103], v2, s[40:43], s28 offen sc1
    s_add_u32 s28, s28, 512
    s_add_u32 m0, s30, 18432
    s_add_u32 s31, s29, 8192
    buffer_load_dwordx4 v5, s[44:47], s29 offen lds
    buffer_load_dwordx4 v5, s[44:47], s31 offen offset:1024 lds
    s_add_u32 s29, s29, 18432
    s_waitcnt vmcnt(42)
    ds_read_b64_tr_b16 v[56:57], v8 offset:22528
    ds_read_b64_tr_b16 v[58:59], v8 offset:23552
    ds_read_b64_tr_b16 v[60:61], v9 offset:22528
    ds_read_b64_tr_b16 v[62:63], v9 offset:23552
    s_waitcnt lgkmcnt(4)
    v_mfma_f32_32x32x16_bf16 v[16:31], v[48:51], v[168:171], v[16:31]
    v_mfma_f32_32x32x16_bf16 v[32:47], v[52:55], v[168:171], v[32:47]
    buffer_load_dwordx4 v[104:107], v2, s[40:43], s28 offen sc1
    s_add_u32 s28, s28, 512
    s_add_u32 m0, s30, 20480
    s_add_u32 s31, s29, 8192
    buffer_load_dwordx4 v5, s[44:47], s29 offen lds
    buffer_load_dwordx4 v5, s[44:47], s31 offen offset:1024 lds
    s_add_u32 s29, s29, 18432
    s_waitcnt vmcnt(42)
    ds_read_b64_tr_b16 v[48:49], v8 offset:24576
    ds_read_b64_tr_b16 v[50:51], v8 offset:25600
    ds_read_b64_tr_b16 v[52:53], v9 offset:24576
    ds_read_b64_tr_b16 v[54:55], v9 offset:25600
    s_waitcnt lgkmcnt(4)
    v_mfma_f32_32x32x16_bf16 v[16:31], v[56:59], v[172:175], v[16:31]
    v_mfma_f32_32x32x16_bf16 v[32:47], v[60:63], v[172:175], v[32:47]
    buffer_load_dwordx4 v[108:111], v2, s[40:43], s28 offen sc1
    s_add_u32 s28, s28, 512
    s_add_u32 m0, s30, 22528
    s_add_u32 s31, s29, 8192
    buffer_load_dwordx4 v5, s[44:47], s29 offen lds
    buffer_load_dwordx4 v5, s[44:47], s31 offen offset:1024 lds
    s_add_u32 s29, s29, 18432
    s_waitcnt vmcnt(42)
    ds_read_b64_tr_b16 v[56:57], v8 offset:26624
    ds_read_b64_tr_b16 v[58:59], v8 offset:27648
    ds_read_b64_tr_b16 v[60:61], v9 offset:26624
    ds_read_b64_tr_b16 v[62:63], v9 offset:27648
    s_waitcnt lgkmcnt(4)
    v_mfma_f32_32x32x16_bf16 v[16:31], v[48:51], v[176:179], v[16:31]
    v_mfma_f32_32x32x16_bf16 v[32:47], v[52:55], v[176:179], v[32:47]
    buffer_load_dwordx4 v[112:115], v2, s[40:43], s28 offen sc1
    s_add_u32 s28, s28, 512
    s_add_u32 m0, s30, 24576
    s_add_u32 s31, s29, 8192
    buffer_load_dwordx4 v5, s[44:47], s29 offen lds
    buffer_load_dwordx4 v5, s[44:47], s31 offen offset:1024 lds
    s_add_u32 s29, s29, 18432
    s_waitcnt vmcnt(42)
    ds_read_b64_tr_b16 v[48:49], v8 offset:28672
    ds_read_b64_tr_b16 v[50:51], v8 offset:29696
    ds_read_b64_tr_b16 v[52:53], v9 offset:28672
    ds_read_b64_tr_b16 v[54:55], v9 offset:29696
    s_waitcnt lgkmcnt(4)
    v_mfma_f32_32x32x16_bf16 v[16:31], v[56:59], v[180:183], v[16:31]
    v_mfma_f32_32x32x16_bf16 v[32:47], v[60:63], v[180:183], v[32:47]
    buffer_load_dwordx4 v[116:119], v2, s[40:43], s28 offen sc1
    s_add_u32 s28, s28, 512
    s_add_u32 m0, s30, 26624
    s_add_u32 s31, s29, 8192
    buffer_load_dwordx4 v5, s[44:47], s29 offen lds
    buffer_load_dwordx4 v5, s[44:47], s31 offen offset:1024 lds
    s_add_u32 s29, s29, 18432
    s_waitcnt vmcnt(42)
    ds_read_b64_tr_b16 v[56:57], v8 offset:30720
    ds_read_b64_tr_b16 v[58:59], v8 offset:31744
    ds_read_b64_tr_b16 v[60:61], v9 offset:30720
    ds_read_b64_tr_b16 v[62:63], v9 offset:31744
    s_waitcnt lgkmcnt(4)
    v_mfma_f32_32x32x16_bf16 v[16:31], v[48:51], v[184:187], v[16:31]
    v_mfma_f32_32x32x16_bf16 v[32:47], v[52:55], v[184:187], v[32:47]
    buffer_load_dwordx4 v[120:123], v2, s[40:43], s28 offen sc1
    s_add_u32 s28, s28, 512
    s_add_u32 m0, s30, 28672
    s_add_u32 s31, s29, 8192
    buffer_load_dwordx4 v5, s[44:47], s29 offen lds
    buffer_load_dwordx4 v5, s[44:47], s31 offen offset:1024 lds
    s_add_u32 s29, s29, 18432
    s_waitcnt vmcnt(42)
    ds_read_b64_tr_b16 v[48:49], v8 offset:0
    ds_read_b64_tr_b16 v[50:51], v8 offset:1024
    ds_read_b64_tr_b16 v[52:53], v9 offset:0
    ds_read_b64_tr_b16 v[54:55], v9 offset:1024
    s_waitcnt lgkmcnt(4)
    v_mfma_f32_32x32x16_bf16 v[16:31], v[56:59], v[188:191], v[16:31]
    v_mfma_f32_32x32x16_bf16 v[32:47], v[60:63], v[188:191], v[32:47]
    buffer_load_dwordx4 v[124:127], v2, s[40:43], s28 offen sc1
    s_add_u32 s28, s28, 512
    s_add_u32 m0, s30, 30720
    s_add_u32 s31, s29, 8192
    buffer_load_dwordx4 v5, s[44:47], s29 offen lds
    buffer_load_dwordx4 v5, s[44:47], s31 offen offset:1024 lds
    s_add_u32 s29, s29, 18432
    s_waitcnt vmcnt(42)
    ds_read_b64_tr_b16 v[56:57], v8 offset:2048
    ds_read_b64_tr_b16 v[58:59], v8 offset:3072
    ds_read_b64_tr_b16 v[60:61], v9 offset:2048
    ds_read_b64_tr_b16 v[62:63], v9 offset:3072
    s_waitcnt lgkmcnt(4)
    v_mfma_f32_32x32x16_bf16 v[16:31], v[48:51], v[64:67], v[16:31]
    v_mfma_f32_32x32x16_bf16 v[32:47], v[52:55], v[64:67], v[32:47]
    s_waitcnt vmcnt(39)
    ds_read_b64_tr_b16 v[48:49], v8 offset:4096
    ds_read_b64_tr_b16 v[50:51], v8 offset:5120
    ds_read_b64_tr_b16 v[52:53], v9 offset:4096
    ds_read_b64_tr_b16 v[54:55], v9 offset:5120
    s_waitcnt lgkmcnt(4)
    v_mfma_f32_32x32x16_bf16 v[16:31], v[56:59], v[68:71], v[16:31]
    v_mfma_f32_32x32x16_bf16 v[32:47], v[60:63], v[68:71], v[32:47]
    s_waitcnt vmcnt(36)
    ds_read_b64_tr_b16 v[56:57], v8 offset:6144
    ds_read_b64_tr_b16 v[58:59], v8 offset:7168
    ds_read_b64_tr_b16 v[60:61], v9 offset:6144
    ds_read_b64_tr_b16 v[62:63], v9 offset:7168
    s_waitcnt lgkmcnt(4)
    v_mfma_f32_32x32x16_bf16 v[16:31], v[48:51], v[72:75], v[16:31]
    v_mfma_f32_32x32x16_bf16 v[32:47], v[52:55], v[72:75], v[32:47]
    s_waitcnt vmcnt(33)
    ds_read_b64_tr_b16 v[48:49], v8 offset:8192
    ds_read_b64_tr_b16 v[50:51], v8 offset:9216
    ds_read_b64_tr_b16 v[52:53], v9 offset:8192
    ds_read_b64_tr_b16 v[54:55], v9 offset:9216
    s_waitcnt lgkmcnt(4)
    v_mfma_f32_32x32x16_bf16 v[16:31], v[56:59], v[76:79], v[16:31]
    v_mfma_f32_32x32x16_bf16 v[32:47], v[60:63], v[76:79], v[32:47]
    s_waitcnt vmcnt(30)
    ds_read_b64_tr_b16 v[56:57], v8 offset:10240
    ds_read_b64_tr_b16 v[58:59], v8 offset:11264
    ds_read_b64_tr_b16 v[60:61], v9 offset:10240
    ds_read_b64_tr_b16 v[62:63], v9 offset:11264
    s_waitcnt lgkmcnt(4)
    v_mfma_f32_32x32x16_bf16 v[16:31], v[48:51], v[80:83], v[16:31]
    v_mfma_f32_32x32x16_bf16 v[32:47], v[52:55], v[80:83], v[32:47]
    s_waitcnt vmcnt(27)
    ds_read_b64_tr_b16 v[48:49], v8 offset:12288
    ds_read_b64_tr_b16 v[50:51], v8 offset:13312
    ds_read_b64_tr_b16 v[52:53], v9 offset:12288
    ds_read_b64_tr_b16 v[54:55], v9 offset:13312
    s_waitcnt lgkmcnt(4)
    v_mfma_f32_32x32x16_bf16 v[16:31], v[56:59], v[84:87], v[16:31]
    v_mfma_f32_32x32x16_bf16 v[32:47], v[60:63], v[84:87], v[32:47]
    s_waitcnt vmcnt(24)
    ds_read_b64_tr_b16 v[56:57], v8 offset:14336
    ds_read_b64_tr_b16 v[58:59], v8 offset:15360
    ds_read_b64_tr_b16 v[60:61], v9 offset:14336
    ds_read_b64_tr_b16 v[62:63], v9 offset:15360
    s_waitcnt lgkmcnt(4)
    v_mfma_f32_32x32x16_bf16 v[16:31], v[48:51], v[88:91], v[16:31]
    v_mfma_f32_32x32x16_bf16 v[32:47], v[52:55], v[88:91], v[32:47]
    s_waitcnt vmcnt(21)
    ds_read_b64_tr_b16 v[48:49], v8 offset:16384
    ds_read_b64_tr_b16 v[50:51], v8 offset:17408
    ds_read_b64_tr_b16 v[52:53], v9 offset:16384
    ds_read_b64_tr_b16 v[54:55], v9 offset:17408
    s_waitcnt lgkmcnt(4)
    v_mfma_f32_32x32x16_bf16 v[16:31], v[56:59], v[92:95], v[16:31]
    v_mfma_f32_32x32x16_bf16 v[32:47], v[60:63], v[92:95], v[32:47]
    s_waitcnt vmcnt(18)
    ds_read_b64_tr_b16 v[56:57], v8 offset:18432
    ds_read_b64_tr_b16 v[58:59], v8 offset:19456
    ds_read_b64_tr_b16 v[60:61], v9 offset:18432
    ds_read_b64_tr_b16 v[62:63], v9 offset:19456
    s_waitcnt lgkmcnt(4)
    v_mfma_f32_32x32x16_bf16 v[16:31], v[48:51], v[96:99], v[16:31]
    v_mfma_f32_32x32x16_bf16 v[32:47], v[52:55], v[96:99], v[32:47]
    s_waitcnt vmcnt(15)
    ds_read_b64_tr_b16 v[48:49], v8 offset:20480
    ds_read_b64_tr_b16 v[50:51], v8 offset:21504
    ds_read_b64_tr_b16 v[52:53], v9 offset:20480
    ds_read_b64_tr_b16 v[54:55], v9 offset:21504
    s_waitcnt lgkmcnt(4)
    v_mfma_f32_32x32x16_bf16 v[16:31], v[56:59], v[100:103], v[16:31]
    v_mfma_f32_32x32x16_bf16 v[32:47], v[60:63], v[100:103], v[32:47]
    s_waitcnt vmcnt(12)
    ds_read_b64_tr_b16 v[56:57], v8 offset:22528
    ds_read_b64_tr_b16 v[58:59], v8 offset:23552
    ds_read_b64_tr_b16 v[60:61], v9 offset:22528
    ds_read_b64_tr_b16 v[62:63], v9 offset:23552
    s_waitcnt lgkmcnt(4)
    v_mfma_f32_32x32x16_bf16 v[16:31], v[48:51], v[104:107], v[16:31]
    v_mfma_f32_32x32x16_bf16 v[32:47], v[52:55], v[104:107], v[32:47]
    s_waitcnt vmcnt(9)
    ds_read_b64_tr_b16 v[48:49], v8 offset:24576
    ds_read_b64_tr_b16 v[50:51], v8 offset:25600
    ds_read_b64_tr_b16 v[52:53], v9 offset:24576
    ds_read_b64_tr_b16 v[54:55], v9 offset:25600
    s_waitcnt lgkmcnt(4)
    v_mfma_f32_32x32x16_bf16 v[16:31], v[56:59], v[108:111], v[16:31]
    v_mfma_f32_32x32x16_bf16 v[32:47], v[60:63], v[108:111], v[32:47]
    s_waitcnt vmcnt(6)
    ds_read_b64_tr_b16 v[56:57], v8 offset:26624
    ds_read_b64_tr_b16 v[58:59], v8 offset:27648
    ds_read_b64_tr_b16 v[60:61], v9 offset:26624
    ds_read_b64_tr_b16 v[62:63], v9 offset:27648
    s_waitcnt lgkmcnt(4)
    v_mfma_f32_32x32x16_bf16 v[16:31], v[48:51], v[112:115], v[16:31]
    v_mfma_f32_32x32x16_bf16 v[32:47], v[52:55], v[112:115], v[32:47]
    s_waitcnt vmcnt(3)
    ds_read_b64_tr_b16 v[48:49], v8 offset:28672
    ds_read_b64_tr_b16 v[50:51], v8 offset:29696
    ds_read_b64_tr_b16 v[52:53], v9 offset:28672
    ds_read_b64_tr_b16 v[54:55], v9 offset:29696
    s_waitcnt lgkmcnt(4)
    v_mfma_f32_32x32x16_bf16 v[16:31], v[56:59], v[116:119], v[16:31]
    v_mfma_f32_32x32x16_bf16 v[32:47], v[60:63], v[116:119], v[32:47]
    s_waitcnt vmcnt(0)
    ds_read_b64_tr_b16 v[56:57], v8 offset:30720
    ds_read_b64_tr_b16 v[58:59], v8 offset:31744
    ds_read_b64_tr_b16 v[60:61], v9 offset:30720
    ds_read_b64_tr_b16 v[62:63], v9 offset:31744
    s_waitcnt lgkmcnt(4)
    v_mfma_f32_32x32x16_bf16 v[16:31], v[48:51], v[120:123], v[16:31]
    v_mfma_f32_32x32x16_bf16 v[32:47], v[52:55], v[120:123], v[32:47]
    s_waitcnt vmcnt(2)
    s_waitcnt lgkmcnt(0)
    v_mfma_f32_32x32x16_bf16 v[16:31], v[56:59], v[124:127], v[16:31]
    v_mfma_f32_32x32x16_bf16 v[32:47], v[60:63], v[124:127], v[32:47]
    v_lshlrev_b32 v10, 4, v0
    v_add_u32 v11, s30, v10
    v_and_b32 v12, 31, v0
    s_mov_b32 s24, 1152
    v_mul_lo_u32 v12, v12, s24
    v_lshlrev_b32 v13, 4, v3
    v_add_u32 v12, v12, v13
    s_mul_i32 s26, s58, 36864
    s_lshl_b32 s25, s59, 7
    s_add_u32 s26, s26, s25
    s_lshl_b32 s25, s23, 5
    s_add_u32 s26, s26, s25
    s_nop 3
    ds_write_b128 v11, v[16:19] offset:0
    ds_write_b128 v11, v[20:23] offset:1024
    ds_write_b128 v11, v[24:27] offset:2048
    ds_write_b128 v11, v[28:31] offset:3072
    ds_write_b128 v11, v[32:35] offset:4096
    ds_write_b128 v11, v[36:39] offset:5120
    ds_write_b128 v11, v[40:43] offset:6144
    ds_write_b128 v11, v[44:47] offset:7168
    s_lshl_b32 s24, s23, 11
    v_add_u32 v14, s24, v10
    v_add_u32 v15, 0x10000, v14
    v_add_u32 v9, 0x20000, v14
    s_barrier
    s_waitcnt lgkmcnt(0)
    s_barrier
    ds_read_b128 v[64:67], v14 offset:0
    ds_read_b128 v[68:71], v14 offset:32768
    ds_read_b128 v[72:75], v15 offset:0
    ds_read_b128 v[76:79], v15 offset:32768
    ds_read_b128 v[80:83], v9 offset:0
    ds_read_b128 v[84:87], v9 offset:8192
    ds_read_b128 v[88:91], v9 offset:16384
    ds_read_b128 v[92:95], v9 offset:24576
    ds_read_b128 v[96:99], v14 offset:1024
    ds_read_b128 v[100:103], v14 offset:33792
    ds_read_b128 v[104:107], v15 offset:1024
    ds_read_b128 v[108:111], v15 offset:33792
    ds_read_b128 v[112:115], v9 offset:1024
    ds_read_b128 v[116:119], v9 offset:9216
    ds_read_b128 v[120:123], v9 offset:17408
    ds_read_b128 v[124:127], v9 offset:25600
    s_waitcnt lgkmcnt(8)
    v_add_f32 v64, v64, v68
    v_add_f32 v72, v72, v76
    v_add_f32 v80, v80, v84
    v_add_f32 v88, v88, v92
    v_add_f32 v64, v64, v72
    v_add_f32 v80, v80, v88
    v_add_f32 v64, v64, v80
    v_add_f32 v65, v65, v69
    v_add_f32 v73, v73, v77
    v_add_f32 v81, v81, v85
    v_add_f32 v89, v89, v93
    v_add_f32 v65, v65, v73
    v_add_f32 v81, v81, v89
    v_add_f32 v65, v65, v81
    v_add_f32 v66, v66, v70
    v_add_f32 v74, v74, v78
    v_add_f32 v82, v82, v86
    v_add_f32 v90, v90, v94
    v_add_f32 v66, v66, v74
    v_add_f32 v82, v82, v90
    v_add_f32 v66, v66, v82
    v_add_f32 v67, v67, v71
    v_add_f32 v75, v75, v79
    v_add_f32 v83, v83, v87
    v_add_f32 v91, v91, v95
    v_add_f32 v67, v67, v75
    v_add_f32 v83, v83, v91
    v_add_f32 v67, v67, v83
    s_waitcnt lgkmcnt(0)
    v_add_f32 v96, v96, v100
    v_add_f32 v104, v104, v108
    v_add_f32 v112, v112, v116
    v_add_f32 v120, v120, v124
    v_add_f32 v96, v96, v104
    v_add_f32 v112, v112, v120
    v_add_f32 v96, v96, v112
    v_add_f32 v97, v97, v101
    v_add_f32 v105, v105, v109
    v_add_f32 v113, v113, v117
    v_add_f32 v121, v121, v125
    v_add_f32 v97, v97, v105
    v_add_f32 v113, v113, v121
    v_add_f32 v97, v97, v113
    v_add_f32 v98, v98, v102
    v_add_f32 v106, v106, v110
    v_add_f32 v114, v114, v118
    v_add_f32 v122, v122, v126
    v_add_f32 v98, v98, v106
    v_add_f32 v114, v114, v122
    v_add_f32 v98, v98, v114
    v_add_f32 v99, v99, v103
    v_add_f32 v107, v107, v111
    v_add_f32 v115, v115, v119
    v_add_f32 v123, v123, v127
    v_add_f32 v99, v99, v107
    v_add_f32 v115, v115, v123
    v_add_f32 v99, v99, v115
    v_cvt_pk_bf16_f32 v16, v64, v65
    v_cvt_pk_bf16_f32 v17, v66, v67
    v_cvt_pk_bf16_f32 v18, v96, v97
    v_cvt_pk_bf16_f32 v19, v98, v99
    s_nop 1
    v_permlane32_swap_b32 v16, v18
    v_permlane32_swap_b32 v17, v19
    buffer_store_dwordx4 v[16:19], v12, s[48:51], s26 offen
L_fin:
    s_endpgm
L_fallback:
    s_barrier
    s_lshl_b32 s50, s23, 15
    s_lshl_b32 s24, s20, 4
    s_add_u32 s24, s24, s22
    s_lshl_b32 s24, s24, 18
    s_add_u32 s44, s6, s24
    s_addc_u32 s45, s7, 0
    s_mov_b32 s46, 262144
    s_mov_b32 s47, 0x20000
    s_add_u32 s52, s8, s24
    s_addc_u32 s53, s9, 0
    s_mov_b32 s54, 262144
    s_mov_b32 s55, 0x20000
    v_lshrrev_b32 v61, 4, v0
    v_and_b32 v62, 15, v0
    v_add_u32 v63, 0, v61
    v_xor_b32 v63, v63, v62
    v_lshlrev_b32 v63, 4, v63
    v_lshlrev_b32 v64, 8, v61
    v_add_u32 v56, v63, v64
    v_add_u32 v63, 4, v61
    v_xor_b32 v63, v63, v62
    v_lshlrev_b32 v63, 4, v63
    v_lshlrev_b32 v64, 8, v61
    v_add_u32 v57, v63, v64
    v_add_u32 v63, 8, v61
    v_xor_b32 v63, v63, v62
    v_lshlrev_b32 v63, 4, v63
    v_lshlrev_b32 v64, 8, v61
    v_add_u32 v58, v63, v64
    v_add_u32 v63, 12, v61
    v_xor_b32 v63, v63, v62
    v_lshlrev_b32 v63, 4, v63
    v_lshlrev_b32 v64, 8, v61
    v_add_u32 v59, v63, v64
    v_lshlrev_b32 v63, 2, v61
    v_xor_b32 v63, v63, v62
    v_lshlrev_b32 v63, 4, v63
    v_lshlrev_b32 v64, 8, v61
    v_add_u32 v60, v63, v64
    v_add_u32 v66, s50, v4
    v_add_u32 v67, s50, v5
    v_add_u32 v68, s50, v6
    v_add_u32 v69, s50, v7
    v_add_u32 v70, s50, v8
    v_add_u32 v71, s50, v9
    v_add_u32 v72, s50, v10
    v_add_u32 v73, s50, v11
    s_add_u32 s51, s50, 8192
    s_sub_u32 s51, s51, 98304
    v_add_u32 v74, s51, v12
    v_add_u32 v75, s51, v13
    v_add_u32 v76, s51, v14
    v_add_u32 v77, s51, v15
    v_mov_b32 v50, 0xff800000
    s_mov_b32 s56, 0
L_fb1:
    s_add_u32 m0, s50, 0
    s_add_u32 s57, s56, 0
    buffer_load_dwordx4 v56, s[44:47], s57 offen offset:0 lds
    buffer_load_dwordx4 v57, s[44:47], s57 offen offset:1024 lds
    buffer_load_dwordx4 v58, s[44:47], s57 offen offset:2048 lds
    buffer_load_dwordx4 v59, s[44:47], s57 offen offset:3072 lds
    s_add_u32 m0, s50, 4096
    s_add_u32 s57, s56, 4096
    buffer_load_dwordx4 v56, s[44:47], s57 offen offset:0 lds
    buffer_load_dwordx4 v57, s[44:47], s57 offen offset:1024 lds
    buffer_load_dwordx4 v58, s[44:47], s57 offen offset:2048 lds
    buffer_load_dwordx4 v59, s[44:47], s57 offen offset:3072 lds
    s_waitcnt vmcnt(0)
    ds_read_b128 a[0:3], v66
    ds_read_b128 a[4:7], v67
    ds_read_b128 a[8:11], v68
    ds_read_b128 a[12:15], v69
    ds_read_b128 a[16:19], v70
    ds_read_b128 a[20:23], v71
    ds_read_b128 a[24:27], v72
    ds_read_b128 a[28:31], v73
    s_waitcnt lgkmcnt(0)
    v_mfma_f32_32x32x16_bf16 v[16:31], a[0:3], v[96:99], 0
    v_mfma_f32_32x32x16_bf16 v[16:31], a[4:7], v[100:103], v[16:31]
    v_mfma_f32_32x32x16_bf16 v[16:31], a[8:11], v[104:107], v[16:31]
    v_mfma_f32_32x32x16_bf16 v[16:31], a[12:15], v[108:111], v[16:31]
    v_mfma_f32_32x32x16_bf16 v[16:31], a[16:19], v[112:115], v[16:31]
    v_mfma_f32_32x32x16_bf16 v[16:31], a[20:23], v[116:119], v[16:31]
    v_mfma_f32_32x32x16_bf16 v[16:31], a[24:27], v[120:123], v[16:31]
    v_mfma_f32_32x32x16_bf16 v[16:31], a[28:31], v[124:127], v[16:31]
    s_nop 7
    s_nop 7
    v_max_f32 v50, v50, v16
    v_max_f32 v50, v50, v17
    v_max_f32 v50, v50, v18
    v_max_f32 v50, v50, v19
    v_max_f32 v50, v50, v20
    v_max_f32 v50, v50, v21
    v_max_f32 v50, v50, v22
    v_max_f32 v50, v50, v23
    v_max_f32 v50, v50, v24
    v_max_f32 v50, v50, v25
    v_max_f32 v50, v50, v26
    v_max_f32 v50, v50, v27
    v_max_f32 v50, v50, v28
    v_max_f32 v50, v50, v29
    v_max_f32 v50, v50, v30
    v_max_f32 v50, v50, v31
    s_add_u32 s56, s56, 8192
    s_cmp_lt_u32 s56, 262144
    s_cbranch_scc1 L_fb1
    v_mov_b32 v49, v50
    s_nop 1
    v_permlane32_swap_b32 v50, v49
    s_nop 1
    v_max_f32 v50, v50, v49
    v_mov_b32 v128, 0
    v_mov_b32 v129, 0
    v_mov_b32 v130, 0
    v_mov_b32 v131, 0
    v_mov_b32 v132, 0
    v_mov_b32 v133, 0
    v_mov_b32 v134, 0
    v_mov_b32 v135, 0
    v_mov_b32 v136, 0
    v_mov_b32 v137, 0
    v_mov_b32 v138, 0
    v_mov_b32 v139, 0
    v_mov_b32 v140, 0
    v_mov_b32 v141, 0
    v_mov_b32 v142, 0
    v_mov_b32 v143, 0
    v_mov_b32 v144, 0
    v_mov_b32 v145, 0
    v_mov_b32 v146, 0
    v_mov_b32 v147, 0
    v_mov_b32 v148, 0
    v_mov_b32 v149, 0
    v_mov_b32 v150, 0
    v_mov_b32 v151, 0
    v_mov_b32 v152, 0
    v_mov_b32 v153, 0
    v_mov_b32 v154, 0
    v_mov_b32 v155, 0
    v_mov_b32 v156, 0
    v_mov_b32 v157, 0
    v_mov_b32 v158, 0
    v_mov_b32 v159, 0
    v_mov_b32 v160, 0
    v_mov_b32 v161, 0
    v_mov_b32 v162, 0
    v_mov_b32 v163, 0
    v_mov_b32 v164, 0
    v_mov_b32 v165, 0
    v_mov_b32 v166, 0
    v_mov_b32 v167, 0
    v_mov_b32 v168, 0
    v_mov_b32 v169, 0
    v_mov_b32 v170, 0
    v_mov_b32 v171, 0
    v_mov_b32 v172, 0
    v_mov_b32 v173, 0
    v_mov_b32 v174, 0
    v_mov_b32 v175, 0
    v_mov_b32 v176, 0
    v_mov_b32 v177, 0
    v_mov_b32 v178, 0
    v_mov_b32 v179, 0
    v_mov_b32 v180, 0
    v_mov_b32 v181, 0
    v_mov_b32 v182, 0
    v_mov_b32 v183, 0
    v_mov_b32 v184, 0
    v_mov_b32 v185, 0
    v_mov_b32 v186, 0
    v_mov_b32 v187, 0
    v_mov_b32 v188, 0
    v_mov_b32 v189, 0
    v_mov_b32 v190, 0
    v_mov_b32 v191, 0
    v_mov_b32 v48, 0
    s_mov_b32 s56, 0
L_fb2:
    s_add_u32 m0, s50, 0
    s_add_u32 s57, s56, 0
    buffer_load_dwordx4 v56, s[44:47], s57 offen offset:0 lds
    buffer_load_dwordx4 v57, s[44:47], s57 offen offset:1024 lds
    buffer_load_dwordx4 v58, s[44:47], s57 offen offset:2048 lds
    buffer_load_dwordx4 v59, s[44:47], s57 offen offset:3072 lds
    s_add_u32 m0, s50, 4096
    s_add_u32 s57, s56, 4096
    buffer_load_dwordx4 v56, s[44:47], s57 offen offset:0 lds
    buffer_load_dwordx4 v57, s[44:47], s57 offen offset:1024 lds
    buffer_load_dwordx4 v58, s[44:47], s57 offen offset:2048 lds
    buffer_load_dwordx4 v59, s[44:47], s57 offen offset:3072 lds
    s_add_u32 m0, s50, 8192
    s_add_u32 s57, s56, 0
    buffer_load_dwordx4 v60, s[52:55], s57 offen offset:0 lds
    buffer_load_dwordx4 v60, s[52:55], s57 offen offset:1024 lds
    buffer_load_dwordx4 v60, s[52:55], s57 offen offset:2048 lds
    buffer_load_dwordx4 v60, s[52:55], s57 offen offset:3072 lds
    s_add_u32 m0, s50, 12288
    s_add_u32 s57, s56, 4096
    buffer_load_dwordx4 v60, s[52:55], s57 offen offset:0 lds
    buffer_load_dwordx4 v60, s[52:55], s57 offen offset:1024 lds
    buffer_load_dwordx4 v60, s[52:55], s57 offen offset:2048 lds
    buffer_load_dwordx4 v60, s[52:55], s57 offen offset:3072 lds
    s_waitcnt vmcnt(0)
    ds_read_b128 a[0:3], v66
    ds_read_b128 a[4:7], v67
    ds_read_b128 a[8:11], v68
    ds_read_b128 a[12:15], v69
    ds_read_b128 a[16:19], v70
    ds_read_b128 a[20:23], v71
    ds_read_b128 a[24:27], v72
    ds_read_b128 a[28:31], v73
    s_waitcnt lgkmcnt(0)
    v_mfma_f32_32x32x16_bf16 v[16:31], a[0:3], v[96:99], 0
    v_mfma_f32_32x32x16_bf16 v[16:31], a[4:7], v[100:103], v[16:31]
    v_mfma_f32_32x32x16_bf16 v[16:31], a[8:11], v[104:107], v[16:31]
    v_mfma_f32_32x32x16_bf16 v[16:31], a[12:15], v[108:111], v[16:31]
    v_mfma_f32_32x32x16_bf16 v[16:31], a[16:19], v[112:115], v[16:31]
    v_mfma_f32_32x32x16_bf16 v[16:31], a[20:23], v[116:119], v[16:31]
    v_mfma_f32_32x32x16_bf16 v[16:31], a[24:27], v[120:123], v[16:31]
    v_mfma_f32_32x32x16_bf16 v[16:31], a[28:31], v[124:127], v[16:31]
    s_nop 7
    s_nop 7
    v_sub_f32 v16, v16, v50
    v_sub_f32 v17, v17, v50
    v_sub_f32 v18, v18, v50
    v_sub_f32 v19, v19, v50
    v_sub_f32 v20, v20, v50
    v_sub_f32 v21, v21, v50
    v_sub_f32 v22, v22, v50
    v_sub_f32 v23, v23, v50
    v_sub_f32 v24, v24, v50
    v_sub_f32 v25, v25, v50
    v_sub_f32 v26, v26, v50
    v_sub_f32 v27, v27, v50
    v_sub_f32 v28, v28, v50
    v_sub_f32 v29, v29, v50
    v_sub_f32 v30, v30, v50
    v_sub_f32 v31, v31, v50
    v_exp_f32 v16, v16
    v_exp_f32 v17, v17
    v_exp_f32 v18, v18
    v_exp_f32 v19, v19
    v_exp_f32 v20, v20
    v_exp_f32 v21, v21
    v_exp_f32 v22, v22
    v_exp_f32 v23, v23
    v_exp_f32 v24, v24
    v_exp_f32 v25, v25
    v_exp_f32 v26, v26
    v_exp_f32 v27, v27
    v_exp_f32 v28, v28
    v_exp_f32 v29, v29
    v_exp_f32 v30, v30
    v_exp_f32 v31, v31
    s_nop 0
    v_add_f32 v48, v48, v16
    v_add_f32 v48, v48, v17
    v_add_f32 v48, v48, v18
    v_add_f32 v48, v48, v19
    v_add_f32 v48, v48, v20
    v_add_f32 v48, v48, v21
    v_add_f32 v48, v48, v22
    v_add_f32 v48, v48, v23
    v_add_f32 v48, v48, v24
    v_add_f32 v48, v48, v25
    v_add_f32 v48, v48, v26
    v_add_f32 v48, v48, v27
    v_add_f32 v48, v48, v28
    v_add_f32 v48, v48, v29
    v_add_f32 v48, v48, v30
    v_add_f32 v48, v48, v31
    v_cvt_pk_bf16_f32 v80, v16, v17
    v_cvt_pk_bf16_f32 v81, v18, v19
    v_cvt_pk_bf16_f32 v82, v20, v21
    v_cvt_pk_bf16_f32 v83, v22, v23
    v_cvt_pk_bf16_f32 v84, v24, v25
    v_cvt_pk_bf16_f32 v85, v26, v27
    v_cvt_pk_bf16_f32 v86, v28, v29
    v_cvt_pk_bf16_f32 v87, v30, v31
    ds_read_b64_tr_b16 a[32:33], v74 offset:0
    ds_read_b64_tr_b16 a[34:35], v74 offset:2048
    ds_read_b64_tr_b16 a[36:37], v75 offset:0
    ds_read_b64_tr_b16 a[38:39], v75 offset:2048
    ds_read_b64_tr_b16 a[40:41], v76 offset:0
    ds_read_b64_tr_b16 a[42:43], v76 offset:2048
    ds_read_b64_tr_b16 a[44:45], v77 offset:0
    ds_read_b64_tr_b16 a[46:47], v77 offset:2048
    ds_read_b64_tr_b16 a[48:49], v74 offset:4096
    ds_read_b64_tr_b16 a[50:51], v74 offset:6144
    ds_read_b64_tr_b16 a[52:53], v75 offset:4096
    ds_read_b64_tr_b16 a[54:55], v75 offset:6144
    ds_read_b64_tr_b16 a[56:57], v76 offset:4096
    ds_read_b64_tr_b16 a[58:59], v76 offset:6144
    ds_read_b64_tr_b16 a[60:61], v77 offset:4096
    ds_read_b64_tr_b16 a[62:63], v77 offset:6144
    s_waitcnt lgkmcnt(0)
    v_mfma_f32_32x32x16_bf16 v[128:143], a[32:35], v[80:83], v[128:143]
    v_mfma_f32_32x32x16_bf16 v[144:159], a[36:39], v[80:83], v[144:159]
    v_mfma_f32_32x32x16_bf16 v[160:175], a[40:43], v[80:83], v[160:175]
    v_mfma_f32_32x32x16_bf16 v[176:191], a[44:47], v[80:83], v[176:191]
    v_mfma_f32_32x32x16_bf16 v[128:143], a[48:51], v[84:87], v[128:143]
    v_mfma_f32_32x32x16_bf16 v[144:159], a[52:55], v[84:87], v[144:159]
    v_mfma_f32_32x32x16_bf16 v[160:175], a[56:59], v[84:87], v[160:175]
    v_mfma_f32_32x32x16_bf16 v[176:191], a[60:63], v[84:87], v[176:191]
    s_add_u32 s56, s56, 8192
    s_cmp_lt_u32 s56, 262144
    s_cbranch_scc1 L_fb2
    s_nop 7
    s_nop 7
    v_mov_b32 v49, v48
    s_nop 1
    v_permlane32_swap_b32 v48, v49
    s_nop 1
    v_add_f32 v48, v48, v49
    s_mov_b32 s52, s16
    s_mov_b32 s53, s17
    s_mov_b32 s54, 256
    s_mov_b32 s55, 0x20000
    v_mov_b32 v18, 0
    buffer_load_dwordx2 v[16:17], v18, s[52:55], 0 offen offset:128 sc1
    v_rcp_f32 v50, v48
    s_mov_b32 s38, 1
    s_branch L_epi
L_end:
    s_endpgm

.section .rodata,"a"
.p2align 6
.amdhsa_kernel standalone__gqa_block_cached__near_ridge_kernel
  .amdhsa_next_free_vgpr 256
  .amdhsa_next_free_sgpr 100
  .amdhsa_accum_offset 192
  .amdhsa_group_segment_fixed_size 0
  .amdhsa_kernarg_size 64
  .amdhsa_user_sgpr_count 2
  .amdhsa_user_sgpr_kernarg_segment_ptr 1
  .amdhsa_system_sgpr_workgroup_id_x 1
.end_amdhsa_kernel
```
